```python
import torch

def _softmax(x, axis=-1):
    return torch.softmax(x, dim=axis)
def _gelu(x):
    return torch.nn.functional.gelu(x, approximate="tanh")
def _silu(x):
    return torch.nn.functional.silu(x)
def _sigmoid(x):
    return torch.sigmoid(x)
def _layernorm(x, axis=-1, eps=1e-5):
    m = x.mean(dim=axis, keepdim=True)
    v = x.var(dim=axis, keepdim=True, unbiased=False)
    return (x - m) / torch.sqrt(v + eps)
def _scatter_add(tgt, idx, src, axis=0):
    return tgt.clone().index_add_(axis, idx, src)
def _segment_sum(src, seg, n):
    out = torch.zeros((n,) + src.shape[1:], dtype=src.dtype)
    return out.index_add_(0, seg, src)
def _pad(x, pw):
    flat = tuple(v for pair in reversed(pw) for v in pair)
    return torch.nn.functional.pad(x, flat)

kernel_name = 'concat_heads__mha_block__ssm_conv_s4d__prompt'

def setup_inputs():

    _w = (lambda a: (lambda t: t.to(torch.bfloat16) if t.is_floating_point() else t)(torch.as_tensor(a)))
    def _A_setup():
        B, S, D, H = 1, 2048, 512, 32
        return {
            "x": _w((lambda *s: torch.randn(*s, dtype=torch.bfloat16) * 0.2)(B, S, D)),
            "wqkv": _w((lambda *s: torch.randn(*s, dtype=torch.bfloat16) * 0.2)(D, 3 * D)),
            "wo": _w((lambda *s: torch.randn(*s, dtype=torch.bfloat16) * 0.05)(D, D)),
        }
    _A_in = _A_setup()

    def _B_setup():
        Bsz, L, D, N = 1, 2048, 512, 128
        return {
            "u": _w((lambda *s: torch.randn(*s, dtype=torch.bfloat16) * 0.05)(Bsz, L, D)),
            "log_A_real": _w((lambda *s: torch.randn(*s, dtype=torch.bfloat16) * 6.4)(D, N) * 0.5),
            "A_imag": _w((lambda *s: torch.randn(*s, dtype=torch.bfloat16) * 0.05)(D, N) * 3.14),
            "C_real": _w((lambda *s: torch.randn(*s, dtype=torch.bfloat16) * 0.4)(D, N) / N ** 0.5),
            "C_imag": _w((lambda *s: torch.randn(*s, dtype=torch.bfloat16) * 0.4)(D, N) / N ** 0.5),
            "log_dt": _w((lambda *s: torch.randn(*s, dtype=torch.bfloat16) * 0.05)(D) * 0.5 - 4.0),
            "D_skip": _w((lambda *s: torch.randn(*s, dtype=torch.bfloat16) * 0.05)(D)),
        }
    _B_in = _B_setup()

    return {
        "A_x": _A_in["x"],
        "A_wqkv": _A_in["wqkv"],
        "A_wo": _A_in["wo"],
        "B_u": _B_in["u"],
        "B_log_A_real": _B_in["log_A_real"],
        "B_A_imag": _B_in["A_imag"],
        "B_C_real": _B_in["C_real"],
        "B_C_imag": _B_in["C_imag"],
        "B_log_dt": _B_in["log_dt"],
        "B_D_skip": _B_in["D_skip"],
    }

def reference(A_x, A_wqkv, A_wo, B_u, B_log_A_real, B_A_imag, B_C_real, B_C_imag, B_log_dt, B_D_skip):
    def _A_ref(x, wqkv, wo):
        B, S, D = x.shape
        H = 32
        Dh = D // H
        qkv = (lambda x, *d: x.permute(*d))((x @ wqkv).reshape(B, S, 3, H, Dh), 2, 0, 3, 1, 4)
        q, k, v = qkv[0], qkv[1], qkv[2]
        scores = torch.einsum("bhqd,bhkd->bhqk", q, k) * (Dh ** -0.5)
        p = _softmax(scores, axis=-1)
        o = torch.einsum("bhqk,bhkd->bhqd", p, v)
        return (lambda x, *d: x.permute(*d))(o, 0, 2, 1, 3).reshape(B, S, D) @ wo

    def _B_ref(u, log_A_real, A_imag, C_real, C_imag, log_dt, D_skip):
        L = u.shape[1]
        dt = torch.exp(log_dt)
        A = -torch.exp(log_A_real) + 1j * A_imag
        C = (C_real + 1j * C_imag) * dt[:, None]
        pos = (lambda x, dt: x.to(dt))(torch.arange(L), log_dt.dtype)
        P = torch.exp((A * dt[:, None])[:, :, None] * pos[None, None, :])
        K = 2.0 * torch.einsum("dn,dnl->dl", C, P).real
        L2 = 2 * L
        u_t = (lambda x, *d: x.permute(*d))(u, 0, 2, 1)
        Kf = (lambda x, *a, **k: torch.fft.rfft(x.float(), *a, **k))(K, L2)
        Uf = (lambda x, *a, **k: torch.fft.rfft(x.float(), *a, **k))(u_t, L2)
        y = (lambda x, *a, **k: torch.fft.irfft(x, *a, **k).to(torch.bfloat16))(Uf * Kf[None, :, :], L2)[:, :, :L]
        y = (lambda x, *d: x.permute(*d))(y, 0, 2, 1)
        return y + u * D_skip[None, None, :]

    a = _A_ref(A_x, A_wqkv, A_wo)
    b = _B_ref(B_u, B_log_A_real, B_A_imag, B_C_real, B_C_imag, B_log_dt, B_D_skip)
    return torch.concatenate([a, b], axis=-1)
```

```asm
; @launch grid=(256,1,1) block=(768,1,1) lds=163840
.amdgcn_target "amdgcn-amd-amdhsa--gfx950"
.text
.globl concat_heads__mha_block__ssm_conv_s4d__prompt_kernel
.p2align 8
.type concat_heads__mha_block__ssm_conv_s4d__prompt_kernel,@function
concat_heads__mha_block__ssm_conv_s4d__prompt_kernel:
KM_START:
    s_cmp_ge_u32 s2, 256
    s_cbranch_scc1 KM_END
    s_load_dwordx2 s[62:63], s[0:1], 96
    v_lshrrev_b32 v1, 6, v0
    v_and_b32 v2, 63, v0
    v_readfirstlane_b32 s24, v1
    s_and_b32 s25, s2, 7
    s_lshr_b32 s26, s2, 3
    s_mov_b32 s61, 18874368
    s_cmp_ge_u32 s24, 8
    s_cbranch_scc1 KM_B
    s_load_dwordx4 s[4:7], s[0:1], 32
    s_load_dwordx4 s[8:11], s[0:1], 48
    s_load_dwordx2 s[12:13], s[0:1], 64
    s_lshl_b32 s28, s25, 6
    s_lshl_b32 s29, s26, 1
    s_add_u32 s28, s28, s29
    s_bfe_u32 s30, s24, 0x10001
    s_and_b32 s31, s24, 1
    s_add_u32 s32, s28, s30
    s_lshl_b32 s33, s32, 7
    s_lshl_b32 s34, s31, 6
    s_add_u32 s33, s33, s34
    v_add_u32 v3, s33, v2
    v_lshlrev_b32 v3, 1, v3
    s_lshl_b32 s33, s32, 1
    v_mov_b32 v4, s33
    s_waitcnt lgkmcnt(0)
    global_load_ushort v160, v3, s[4:5]
    global_load_ushort v161, v3, s[6:7]
    global_load_ushort v162, v3, s[8:9]
    global_load_ushort v163, v3, s[10:11]
    global_load_ushort v164, v4, s[12:13]
    s_cmp_ge_u32 s24, 4
    s_cbranch_scc1 KM_A47
    s_load_dwordx2 s[50:51], s[0:1], 88
    s_lshr_b32 s27, s25, 1
    s_lshl_b32 s27, s27, 3
    s_and_b32 s28, s26, 7
    s_add_u32 s27, s27, s28
    s_and_b32 s28, s25, 1
    s_lshl_b32 s28, s28, 2
    s_lshr_b32 s29, s26, 3
    s_add_u32 s28, s28, s29
    s_and_b32 s40, s24, 1
    s_lshr_b32 s41, s24, 1
    v_and_b32 v9, 31, v2
    v_lshrrev_b32 v10, 5, v2
    v_bfe_u32 v11, v9, 1, 3
    v_xor_b32 v11, v11, v10
    v_lshlrev_b32 v6, 7, v9
    s_lshl_b32 s29, s40, 12
    v_add_u32 v6, s29, v6
    v_lshl_add_u32 v6, v11, 4, v6
    v_xor_b32 v7, 32, v6
    v_xor_b32 v15, 64, v6
    v_xor_b32 v3, 96, v6
    v_bfe_u32 v11, v2, 2, 2
    v_lshl_add_u32 v13, v10, 3, v11
    v_mul_u32_u24 v8, 384, v13
    v_bfe_u32 v11, v2, 3, 1
    v_xor_b32 v11, s41, v11
    v_lshl_add_u32 v8, v11, 6, v8
    v_bfe_u32 v11, v2, 4, 1
    v_lshl_add_u32 v8, v11, 5, v8
    v_and_b32 v11, 3, v2
    v_lshl_add_u32 v8, v11, 3, v8
    v_add_u32 v8, 24576, v8
    v_add_u32 v4, 49152, v8
    v_lshlrev_b32 v12, 4, v2
    v_and_b32 v11, 19, v9
    v_and_b32 v13, 4, v9
    v_lshl_or_b32 v11, v13, 1, v11
    v_and_b32 v13, 8, v9
    v_lshrrev_b32 v13, 1, v13
    v_or_b32 v11, v11, v13
    v_lshl_add_u32 v11, v10, 5, v11
    v_lshlrev_b32 v13, 4, v11
    v_lshrrev_b32 v11, 4, v9
    v_lshlrev_b32 v14, 16, v11
    v_lshl_add_u32 v14, v10, 8, v14
    v_and_b32 v11, 15, v9
    v_lshl_add_u32 v14, v11, 4, v14
    s_mov_b32 s20, s62
    s_and_b32 s21, s63, 0xffff
    s_mov_b32 s22, 6291456
    s_mov_b32 s23, 0x20000
    v_mov_b32 v5, 0
    s_barrier
    ds_read_b128 v[16:19], v6 offset:0
    ds_read_b64_tr_b16 v[24:25], v8 offset:0
    ds_read_b64_tr_b16 v[26:27], v8 offset:1536
    ds_read_b64_tr_b16 v[28:29], v8 offset:128
    ds_read_b64_tr_b16 v[30:31], v8 offset:1664
    ds_read_b64_tr_b16 v[32:33], v8 offset:256
    ds_read_b64_tr_b16 v[34:35], v8 offset:1792
    ds_read_b128 v[20:23], v7 offset:0
    ds_read_b64_tr_b16 v[36:37], v8 offset:6144
    ds_read_b64_tr_b16 v[38:39], v8 offset:7680
    ds_read_b64_tr_b16 v[40:41], v8 offset:6272
    ds_read_b64_tr_b16 v[42:43], v8 offset:7808
    ds_read_b64_tr_b16 v[44:45], v8 offset:6400
    ds_read_b64_tr_b16 v[46:47], v8 offset:7936
    s_waitcnt lgkmcnt(0)
    s_barrier
    v_mfma_f32_32x32x16_bf16 v[80:95], v[24:27], v[16:19], 0
    ds_read_b128 v[48:51], v15 offset:0
    ds_read_b64_tr_b16 v[56:57], v8 offset:12288
    ds_read_b64_tr_b16 v[58:59], v8 offset:13824
    v_mfma_f32_32x32x16_bf16 v[96:111], v[28:31], v[16:19], 0
    ds_read_b64_tr_b16 v[60:61], v8 offset:12416
    ds_read_b64_tr_b16 v[62:63], v8 offset:13952
    ds_read_b64_tr_b16 v[64:65], v8 offset:12544
    v_mfma_f32_32x32x16_bf16 v[112:127], v[16:19], v[32:35], 0
    ds_read_b64_tr_b16 v[66:67], v8 offset:14080
    ds_read_b128 v[52:55], v3 offset:0
    ds_read_b64_tr_b16 v[68:69], v8 offset:18432
    v_mfma_f32_32x32x16_bf16 v[80:95], v[36:39], v[20:23], v[80:95]
    ds_read_b64_tr_b16 v[70:71], v8 offset:19968
    ds_read_b64_tr_b16 v[72:73], v8 offset:18560
    ds_read_b64_tr_b16 v[74:75], v8 offset:20096
    v_mfma_f32_32x32x16_bf16 v[96:111], v[40:43], v[20:23], v[96:111]
    ds_read_b64_tr_b16 v[76:77], v8 offset:18688
    v_mfma_f32_32x32x16_bf16 v[112:127], v[20:23], v[44:47], v[112:127]
    ds_read_b64_tr_b16 v[78:79], v8 offset:20224
    s_waitcnt lgkmcnt(0)
    s_barrier
    v_mfma_f32_32x32x16_bf16 v[80:95], v[56:59], v[48:51], v[80:95]
    ds_read_b128 v[16:19], v6 offset:8192
    ds_read_b64_tr_b16 v[24:25], v8 offset:24576
    ds_read_b64_tr_b16 v[26:27], v8 offset:26112
    v_mfma_f32_32x32x16_bf16 v[96:111], v[60:63], v[48:51], v[96:111]
    ds_read_b64_tr_b16 v[28:29], v8 offset:24704
    ds_read_b64_tr_b16 v[30:31], v8 offset:26240
    ds_read_b64_tr_b16 v[32:33], v8 offset:24832
    v_mfma_f32_32x32x16_bf16 v[112:127], v[48:51], v[64:67], v[112:127]
    ds_read_b64_tr_b16 v[34:35], v8 offset:26368
    ds_read_b128 v[20:23], v7 offset:8192
    ds_read_b64_tr_b16 v[36:37], v8 offset:30720
    v_mfma_f32_32x32x16_bf16 v[80:95], v[68:71], v[52:55], v[80:95]
    ds_read_b64_tr_b16 v[38:39], v8 offset:32256
    ds_read_b64_tr_b16 v[40:41], v8 offset:30848
    ds_read_b64_tr_b16 v[42:43], v8 offset:32384
    v_mfma_f32_32x32x16_bf16 v[96:111], v[72:75], v[52:55], v[96:111]
    ds_read_b64_tr_b16 v[44:45], v8 offset:30976
    v_mfma_f32_32x32x16_bf16 v[112:127], v[52:55], v[76:79], v[112:127]
    ds_read_b64_tr_b16 v[46:47], v8 offset:32512
    s_waitcnt lgkmcnt(0)
    s_barrier
    v_mfma_f32_32x32x16_bf16 v[80:95], v[24:27], v[16:19], v[80:95]
    ds_read_b128 v[48:51], v15 offset:8192
    ds_read_b64_tr_b16 v[56:57], v8 offset:36864
    ds_read_b64_tr_b16 v[58:59], v8 offset:38400
    v_mfma_f32_32x32x16_bf16 v[96:111], v[28:31], v[16:19], v[96:111]
    ds_read_b64_tr_b16 v[60:61], v8 offset:36992
    ds_read_b64_tr_b16 v[62:63], v8 offset:38528
    ds_read_b64_tr_b16 v[64:65], v8 offset:37120
    v_mfma_f32_32x32x16_bf16 v[112:127], v[16:19], v[32:35], v[112:127]
    ds_read_b64_tr_b16 v[66:67], v8 offset:38656
    ds_read_b128 v[52:55], v3 offset:8192
    ds_read_b64_tr_b16 v[68:69], v8 offset:43008
    v_mfma_f32_32x32x16_bf16 v[80:95], v[36:39], v[20:23], v[80:95]
    ds_read_b64_tr_b16 v[70:71], v8 offset:44544
    ds_read_b64_tr_b16 v[72:73], v8 offset:43136
    ds_read_b64_tr_b16 v[74:75], v8 offset:44672
    v_mfma_f32_32x32x16_bf16 v[96:111], v[40:43], v[20:23], v[96:111]
    ds_read_b64_tr_b16 v[76:77], v8 offset:43264
    v_mfma_f32_32x32x16_bf16 v[112:127], v[20:23], v[44:47], v[112:127]
    ds_read_b64_tr_b16 v[78:79], v8 offset:44800
    s_waitcnt lgkmcnt(0)
    s_barrier
    v_mfma_f32_32x32x16_bf16 v[80:95], v[56:59], v[48:51], v[80:95]
    ds_read_b128 v[16:19], v6 offset:16384
    ds_read_b64_tr_b16 v[24:25], v4 offset:0
    ds_read_b64_tr_b16 v[26:27], v4 offset:1536
    v_mfma_f32_32x32x16_bf16 v[96:111], v[60:63], v[48:51], v[96:111]
    ds_read_b64_tr_b16 v[28:29], v4 offset:128
    ds_read_b64_tr_b16 v[30:31], v4 offset:1664
    ds_read_b64_tr_b16 v[32:33], v4 offset:256
    v_mfma_f32_32x32x16_bf16 v[112:127], v[48:51], v[64:67], v[112:127]
    ds_read_b64_tr_b16 v[34:35], v4 offset:1792
    ds_read_b128 v[20:23], v7 offset:16384
    ds_read_b64_tr_b16 v[36:37], v4 offset:6144
    v_mfma_f32_32x32x16_bf16 v[80:95], v[68:71], v[52:55], v[80:95]
    ds_read_b64_tr_b16 v[38:39], v4 offset:7680
    ds_read_b64_tr_b16 v[40:41], v4 offset:6272
    ds_read_b64_tr_b16 v[42:43], v4 offset:7808
    v_mfma_f32_32x32x16_bf16 v[96:111], v[72:75], v[52:55], v[96:111]
    ds_read_b64_tr_b16 v[44:45], v4 offset:6400
    v_mfma_f32_32x32x16_bf16 v[112:127], v[52:55], v[76:79], v[112:127]
    ds_read_b64_tr_b16 v[46:47], v4 offset:7936
    s_waitcnt lgkmcnt(0)
    s_barrier
    v_mfma_f32_32x32x16_bf16 v[80:95], v[24:27], v[16:19], v[80:95]
    ds_read_b128 v[48:51], v15 offset:16384
    ds_read_b64_tr_b16 v[56:57], v8 offset:0
    ds_read_b64_tr_b16 v[58:59], v8 offset:1536
    v_mfma_f32_32x32x16_bf16 v[96:111], v[28:31], v[16:19], v[96:111]
    ds_read_b64_tr_b16 v[60:61], v8 offset:128
    ds_read_b64_tr_b16 v[62:63], v8 offset:1664
    ds_read_b64_tr_b16 v[64:65], v8 offset:256
    v_mfma_f32_32x32x16_bf16 v[112:127], v[16:19], v[32:35], v[112:127]
    ds_read_b64_tr_b16 v[66:67], v8 offset:1792
    ds_read_b128 v[52:55], v3 offset:16384
    ds_read_b64_tr_b16 v[68:69], v8 offset:6144
    v_mfma_f32_32x32x16_bf16 v[80:95], v[36:39], v[20:23], v[80:95]
    ds_read_b64_tr_b16 v[70:71], v8 offset:7680
    ds_read_b64_tr_b16 v[72:73], v8 offset:6272
    ds_read_b64_tr_b16 v[74:75], v8 offset:7808
    v_mfma_f32_32x32x16_bf16 v[96:111], v[40:43], v[20:23], v[96:111]
    ds_read_b64_tr_b16 v[76:77], v8 offset:6400
    v_mfma_f32_32x32x16_bf16 v[112:127], v[20:23], v[44:47], v[112:127]
    ds_read_b64_tr_b16 v[78:79], v8 offset:7936
    s_waitcnt lgkmcnt(0)
    s_barrier
    v_mfma_f32_32x32x16_bf16 v[80:95], v[56:59], v[48:51], v[80:95]
    ds_read_b128 v[16:19], v6 offset:0
    ds_read_b64_tr_b16 v[24:25], v8 offset:12288
    ds_read_b64_tr_b16 v[26:27], v8 offset:13824
    v_mfma_f32_32x32x16_bf16 v[96:111], v[60:63], v[48:51], v[96:111]
    ds_read_b64_tr_b16 v[28:29], v8 offset:12416
    ds_read_b64_tr_b16 v[30:31], v8 offset:13952
    ds_read_b64_tr_b16 v[32:33], v8 offset:12544
    v_mfma_f32_32x32x16_bf16 v[112:127], v[48:51], v[64:67], v[112:127]
    ds_read_b64_tr_b16 v[34:35], v8 offset:14080
    ds_read_b128 v[20:23], v7 offset:0
    ds_read_b64_tr_b16 v[36:37], v8 offset:18432
    v_mfma_f32_32x32x16_bf16 v[80:95], v[68:71], v[52:55], v[80:95]
    ds_read_b64_tr_b16 v[38:39], v8 offset:19968
    ds_read_b64_tr_b16 v[40:41], v8 offset:18560
    ds_read_b64_tr_b16 v[42:43], v8 offset:20096
    v_mfma_f32_32x32x16_bf16 v[96:111], v[72:75], v[52:55], v[96:111]
    ds_read_b64_tr_b16 v[44:45], v8 offset:18688
    v_mfma_f32_32x32x16_bf16 v[112:127], v[52:55], v[76:79], v[112:127]
    ds_read_b64_tr_b16 v[46:47], v8 offset:20224
    s_waitcnt lgkmcnt(0)
    s_barrier
    v_mfma_f32_32x32x16_bf16 v[80:95], v[24:27], v[16:19], v[80:95]
    ds_read_b128 v[48:51], v15 offset:0
    ds_read_b64_tr_b16 v[56:57], v8 offset:24576
    ds_read_b64_tr_b16 v[58:59], v8 offset:26112
    v_mfma_f32_32x32x16_bf16 v[96:111], v[28:31], v[16:19], v[96:111]
    ds_read_b64_tr_b16 v[60:61], v8 offset:24704
    ds_read_b64_tr_b16 v[62:63], v8 offset:26240
    ds_read_b64_tr_b16 v[64:65], v8 offset:24832
    v_mfma_f32_32x32x16_bf16 v[112:127], v[16:19], v[32:35], v[112:127]
    ds_read_b64_tr_b16 v[66:67], v8 offset:26368
    ds_read_b128 v[52:55], v3 offset:0
    ds_read_b64_tr_b16 v[68:69], v8 offset:30720
    v_mfma_f32_32x32x16_bf16 v[80:95], v[36:39], v[20:23], v[80:95]
    ds_read_b64_tr_b16 v[70:71], v8 offset:32256
    ds_read_b64_tr_b16 v[72:73], v8 offset:30848
    ds_read_b64_tr_b16 v[74:75], v8 offset:32384
    v_mfma_f32_32x32x16_bf16 v[96:111], v[40:43], v[20:23], v[96:111]
    ds_read_b64_tr_b16 v[76:77], v8 offset:30976
    v_mfma_f32_32x32x16_bf16 v[112:127], v[20:23], v[44:47], v[112:127]
    ds_read_b64_tr_b16 v[78:79], v8 offset:32512
    s_waitcnt lgkmcnt(0)
    s_barrier
    v_mfma_f32_32x32x16_bf16 v[80:95], v[56:59], v[48:51], v[80:95]
    ds_read_b128 v[16:19], v6 offset:8192
    ds_read_b64_tr_b16 v[24:25], v8 offset:36864
    ds_read_b64_tr_b16 v[26:27], v8 offset:38400
    v_mfma_f32_32x32x16_bf16 v[96:111], v[60:63], v[48:51], v[96:111]
    ds_read_b64_tr_b16 v[28:29], v8 offset:36992
    ds_read_b64_tr_b16 v[30:31], v8 offset:38528
    ds_read_b64_tr_b16 v[32:33], v8 offset:37120
    v_mfma_f32_32x32x16_bf16 v[112:127], v[48:51], v[64:67], v[112:127]
    ds_read_b64_tr_b16 v[34:35], v8 offset:38656
    ds_read_b128 v[20:23], v7 offset:8192
    ds_read_b64_tr_b16 v[36:37], v8 offset:43008
    v_mfma_f32_32x32x16_bf16 v[80:95], v[68:71], v[52:55], v[80:95]
    ds_read_b64_tr_b16 v[38:39], v8 offset:44544
    ds_read_b64_tr_b16 v[40:41], v8 offset:43136
    ds_read_b64_tr_b16 v[42:43], v8 offset:44672
    v_mfma_f32_32x32x16_bf16 v[96:111], v[72:75], v[52:55], v[96:111]
    ds_read_b64_tr_b16 v[44:45], v8 offset:43264
    v_mfma_f32_32x32x16_bf16 v[112:127], v[52:55], v[76:79], v[112:127]
    ds_read_b64_tr_b16 v[46:47], v8 offset:44800
    s_waitcnt lgkmcnt(0)
    s_barrier
    global_load_dword v159, v5, s[50:51] sc1
    v_mfma_f32_32x32x16_bf16 v[80:95], v[24:27], v[16:19], v[80:95]
    ds_read_b128 v[48:51], v15 offset:8192
    ds_read_b64_tr_b16 v[56:57], v4 offset:0
    ds_read_b64_tr_b16 v[58:59], v4 offset:1536
    v_mfma_f32_32x32x16_bf16 v[96:111], v[28:31], v[16:19], v[96:111]
    ds_read_b64_tr_b16 v[60:61], v4 offset:128
    ds_read_b64_tr_b16 v[62:63], v4 offset:1664
    ds_read_b64_tr_b16 v[64:65], v4 offset:256
    v_mfma_f32_32x32x16_bf16 v[112:127], v[16:19], v[32:35], v[112:127]
    ds_read_b64_tr_b16 v[66:67], v4 offset:1792
    ds_read_b128 v[52:55], v3 offset:8192
    ds_read_b64_tr_b16 v[68:69], v4 offset:6144
    v_mfma_f32_32x32x16_bf16 v[80:95], v[36:39], v[20:23], v[80:95]
    ds_read_b64_tr_b16 v[70:71], v4 offset:7680
    ds_read_b64_tr_b16 v[72:73], v4 offset:6272
    ds_read_b64_tr_b16 v[74:75], v4 offset:7808
    v_mfma_f32_32x32x16_bf16 v[96:111], v[40:43], v[20:23], v[96:111]
    ds_read_b64_tr_b16 v[76:77], v4 offset:6400
    v_mfma_f32_32x32x16_bf16 v[112:127], v[20:23], v[44:47], v[112:127]
    ds_read_b64_tr_b16 v[78:79], v4 offset:7936
    s_waitcnt lgkmcnt(0)
    s_barrier
    v_mfma_f32_32x32x16_bf16 v[80:95], v[56:59], v[48:51], v[80:95]
    ds_read_b128 v[16:19], v6 offset:16384
    ds_read_b64_tr_b16 v[24:25], v8 offset:0
    ds_read_b64_tr_b16 v[26:27], v8 offset:1536
    v_mfma_f32_32x32x16_bf16 v[96:111], v[60:63], v[48:51], v[96:111]
    ds_read_b64_tr_b16 v[28:29], v8 offset:128
    ds_read_b64_tr_b16 v[30:31], v8 offset:1664
    ds_read_b64_tr_b16 v[32:33], v8 offset:256
    v_mfma_f32_32x32x16_bf16 v[112:127], v[48:51], v[64:67], v[112:127]
    ds_read_b64_tr_b16 v[34:35], v8 offset:1792
    ds_read_b128 v[20:23], v7 offset:16384
    ds_read_b64_tr_b16 v[36:37], v8 offset:6144
    v_mfma_f32_32x32x16_bf16 v[80:95], v[68:71], v[52:55], v[80:95]
    ds_read_b64_tr_b16 v[38:39], v8 offset:7680
    ds_read_b64_tr_b16 v[40:41], v8 offset:6272
    ds_read_b64_tr_b16 v[42:43], v8 offset:7808
    v_mfma_f32_32x32x16_bf16 v[96:111], v[72:75], v[52:55], v[96:111]
    ds_read_b64_tr_b16 v[44:45], v8 offset:6400
    v_mfma_f32_32x32x16_bf16 v[112:127], v[52:55], v[76:79], v[112:127]
    ds_read_b64_tr_b16 v[46:47], v8 offset:7936
    s_waitcnt lgkmcnt(0)
    s_barrier
    v_mfma_f32_32x32x16_bf16 v[80:95], v[24:27], v[16:19], v[80:95]
    ds_read_b128 v[48:51], v15 offset:16384
    ds_read_b64_tr_b16 v[56:57], v8 offset:12288
    ds_read_b64_tr_b16 v[58:59], v8 offset:13824
    v_mfma_f32_32x32x16_bf16 v[96:111], v[28:31], v[16:19], v[96:111]
    ds_read_b64_tr_b16 v[60:61], v8 offset:12416
    ds_read_b64_tr_b16 v[62:63], v8 offset:13952
    ds_read_b64_tr_b16 v[64:65], v8 offset:12544
    v_mfma_f32_32x32x16_bf16 v[112:127], v[16:19], v[32:35], v[112:127]
    ds_read_b64_tr_b16 v[66:67], v8 offset:14080
    ds_read_b128 v[52:55], v3 offset:16384
    ds_read_b64_tr_b16 v[68:69], v8 offset:18432
    v_mfma_f32_32x32x16_bf16 v[80:95], v[36:39], v[20:23], v[80:95]
    ds_read_b64_tr_b16 v[70:71], v8 offset:19968
    ds_read_b64_tr_b16 v[72:73], v8 offset:18560
    ds_read_b64_tr_b16 v[74:75], v8 offset:20096
    v_mfma_f32_32x32x16_bf16 v[96:111], v[40:43], v[20:23], v[96:111]
    ds_read_b64_tr_b16 v[76:77], v8 offset:18688
    v_mfma_f32_32x32x16_bf16 v[112:127], v[20:23], v[44:47], v[112:127]
    ds_read_b64_tr_b16 v[78:79], v8 offset:20224
    s_waitcnt lgkmcnt(0)
    s_barrier
    v_mfma_f32_32x32x16_bf16 v[80:95], v[56:59], v[48:51], v[80:95]
    ds_read_b128 v[16:19], v6 offset:0
    ds_read_b64_tr_b16 v[24:25], v8 offset:24576
    ds_read_b64_tr_b16 v[26:27], v8 offset:26112
    v_mfma_f32_32x32x16_bf16 v[96:111], v[60:63], v[48:51], v[96:111]
    ds_read_b64_tr_b16 v[28:29], v8 offset:24704
    ds_read_b64_tr_b16 v[30:31], v8 offset:26240
    ds_read_b64_tr_b16 v[32:33], v8 offset:24832
    v_mfma_f32_32x32x16_bf16 v[112:127], v[48:51], v[64:67], v[112:127]
    ds_read_b64_tr_b16 v[34:35], v8 offset:26368
    ds_read_b128 v[20:23], v7 offset:0
    ds_read_b64_tr_b16 v[36:37], v8 offset:30720
    v_mfma_f32_32x32x16_bf16 v[80:95], v[68:71], v[52:55], v[80:95]
    ds_read_b64_tr_b16 v[38:39], v8 offset:32256
    ds_read_b64_tr_b16 v[40:41], v8 offset:30848
    ds_read_b64_tr_b16 v[42:43], v8 offset:32384
    v_mfma_f32_32x32x16_bf16 v[96:111], v[72:75], v[52:55], v[96:111]
    ds_read_b64_tr_b16 v[44:45], v8 offset:30976
    v_mfma_f32_32x32x16_bf16 v[112:127], v[52:55], v[76:79], v[112:127]
    ds_read_b64_tr_b16 v[46:47], v8 offset:32512
    s_waitcnt lgkmcnt(0)
    s_barrier
    v_mfma_f32_32x32x16_bf16 v[80:95], v[24:27], v[16:19], v[80:95]
    ds_read_b128 v[48:51], v15 offset:0
    ds_read_b64_tr_b16 v[56:57], v8 offset:36864
    ds_read_b64_tr_b16 v[58:59], v8 offset:38400
    v_mfma_f32_32x32x16_bf16 v[96:111], v[28:31], v[16:19], v[96:111]
    ds_read_b64_tr_b16 v[60:61], v8 offset:36992
    ds_read_b64_tr_b16 v[62:63], v8 offset:38528
    ds_read_b64_tr_b16 v[64:65], v8 offset:37120
    v_mfma_f32_32x32x16_bf16 v[112:127], v[16:19], v[32:35], v[112:127]
    ds_read_b64_tr_b16 v[66:67], v8 offset:38656
    ds_read_b128 v[52:55], v3 offset:0
    ds_read_b64_tr_b16 v[68:69], v8 offset:43008
    v_mfma_f32_32x32x16_bf16 v[80:95], v[36:39], v[20:23], v[80:95]
    ds_read_b64_tr_b16 v[70:71], v8 offset:44544
    ds_read_b64_tr_b16 v[72:73], v8 offset:43136
    ds_read_b64_tr_b16 v[74:75], v8 offset:44672
    v_mfma_f32_32x32x16_bf16 v[96:111], v[40:43], v[20:23], v[96:111]
    ds_read_b64_tr_b16 v[76:77], v8 offset:43264
    v_mfma_f32_32x32x16_bf16 v[112:127], v[20:23], v[44:47], v[112:127]
    ds_read_b64_tr_b16 v[78:79], v8 offset:44800
    s_waitcnt lgkmcnt(0)
    s_barrier
    v_mfma_f32_32x32x16_bf16 v[80:95], v[56:59], v[48:51], v[80:95]
    ds_read_b128 v[16:19], v6 offset:8192
    ds_read_b64_tr_b16 v[24:25], v4 offset:0
    ds_read_b64_tr_b16 v[26:27], v4 offset:1536
    v_mfma_f32_32x32x16_bf16 v[96:111], v[60:63], v[48:51], v[96:111]
    ds_read_b64_tr_b16 v[28:29], v4 offset:128
    ds_read_b64_tr_b16 v[30:31], v4 offset:1664
    ds_read_b64_tr_b16 v[32:33], v4 offset:256
    v_mfma_f32_32x32x16_bf16 v[112:127], v[48:51], v[64:67], v[112:127]
    ds_read_b64_tr_b16 v[34:35], v4 offset:1792
    ds_read_b128 v[20:23], v7 offset:8192
    ds_read_b64_tr_b16 v[36:37], v4 offset:6144
    v_mfma_f32_32x32x16_bf16 v[80:95], v[68:71], v[52:55], v[80:95]
    ds_read_b64_tr_b16 v[38:39], v4 offset:7680
    ds_read_b64_tr_b16 v[40:41], v4 offset:6272
    ds_read_b64_tr_b16 v[42:43], v4 offset:7808
    v_mfma_f32_32x32x16_bf16 v[96:111], v[72:75], v[52:55], v[96:111]
    ds_read_b64_tr_b16 v[44:45], v4 offset:6400
    v_mfma_f32_32x32x16_bf16 v[112:127], v[52:55], v[76:79], v[112:127]
    ds_read_b64_tr_b16 v[46:47], v4 offset:7936
    s_waitcnt lgkmcnt(0)
    s_barrier
    v_mfma_f32_32x32x16_bf16 v[80:95], v[24:27], v[16:19], v[80:95]
    ds_read_b128 v[48:51], v15 offset:8192
    ds_read_b64_tr_b16 v[56:57], v8 offset:0
    ds_read_b64_tr_b16 v[58:59], v8 offset:1536
    v_mfma_f32_32x32x16_bf16 v[96:111], v[28:31], v[16:19], v[96:111]
    ds_read_b64_tr_b16 v[60:61], v8 offset:128
    ds_read_b64_tr_b16 v[62:63], v8 offset:1664
    ds_read_b64_tr_b16 v[64:65], v8 offset:256
    v_mfma_f32_32x32x16_bf16 v[112:127], v[16:19], v[32:35], v[112:127]
    ds_read_b64_tr_b16 v[66:67], v8 offset:1792
    ds_read_b128 v[52:55], v3 offset:8192
    ds_read_b64_tr_b16 v[68:69], v8 offset:6144
    v_mfma_f32_32x32x16_bf16 v[80:95], v[36:39], v[20:23], v[80:95]
    ds_read_b64_tr_b16 v[70:71], v8 offset:7680
    ds_read_b64_tr_b16 v[72:73], v8 offset:6272
    ds_read_b64_tr_b16 v[74:75], v8 offset:7808
    v_mfma_f32_32x32x16_bf16 v[96:111], v[40:43], v[20:23], v[96:111]
    ds_read_b64_tr_b16 v[76:77], v8 offset:6400
    v_mfma_f32_32x32x16_bf16 v[112:127], v[20:23], v[44:47], v[112:127]
    ds_read_b64_tr_b16 v[78:79], v8 offset:7936
    s_waitcnt lgkmcnt(0)
    s_barrier
    v_mfma_f32_32x32x16_bf16 v[80:95], v[56:59], v[48:51], v[80:95]
    v_mfma_f32_32x32x16_bf16 v[96:111], v[60:63], v[48:51], v[96:111]
    v_mfma_f32_32x32x16_bf16 v[112:127], v[48:51], v[64:67], v[112:127]
    v_mfma_f32_32x32x16_bf16 v[80:95], v[68:71], v[52:55], v[80:95]
    v_mfma_f32_32x32x16_bf16 v[96:111], v[72:75], v[52:55], v[96:111]
    v_mfma_f32_32x32x16_bf16 v[112:127], v[52:55], v[76:79], v[112:127]
    s_nop 13
    s_mov_b32 s33, 0x3eb8aa3b
    s_lshl_b32 s36, s28, 2
    s_lshl_b32 s37, s41, 1
    s_add_u32 s36, s36, s37
    s_lshl_b32 s36, s36, 6
    s_lshl_b32 s37, s27, 1
    s_add_u32 s36, s36, s37
    s_add_u32 s36, s36, s40
    s_lshl_b32 s36, s36, 10
    v_cvt_pk_bf16_f32 v24, v96, v97
    v_cvt_pk_bf16_f32 v25, v98, v99
    v_cvt_pk_bf16_f32 v26, v100, v101
    v_cvt_pk_bf16_f32 v27, v102, v103
    v_cvt_pk_bf16_f32 v28, v104, v105
    v_cvt_pk_bf16_f32 v29, v106, v107
    v_cvt_pk_bf16_f32 v30, v108, v109
    v_cvt_pk_bf16_f32 v31, v110, v111
    s_add_u32 s37, s36, 2097152
    buffer_store_dwordx4 v[24:27], v13, s[20:23], s37 offen sc1
    s_add_u32 s38, s36, 2162688
    buffer_store_dwordx4 v[28:31], v13, s[20:23], s38 offen sc1
    v_cvt_pk_bf16_f32 v32, v112, v113
    v_cvt_pk_bf16_f32 v33, v114, v115
    v_cvt_pk_bf16_f32 v34, v116, v117
    v_cvt_pk_bf16_f32 v35, v118, v119
    v_cvt_pk_bf16_f32 v36, v120, v121
    v_cvt_pk_bf16_f32 v37, v122, v123
    v_cvt_pk_bf16_f32 v38, v124, v125
    v_cvt_pk_bf16_f32 v39, v126, v127
    s_add_u32 s37, s36, 4194304
    buffer_store_dwordx4 v[32:35], v14, s[20:23], s37 offen sc1
    s_add_u32 s38, s36, 4194816
    buffer_store_dwordx4 v[36:39], v14, s[20:23], s38 offen sc1
    v_mul_f32 v80, s33, v80
    v_mul_f32 v81, s33, v81
    v_mul_f32 v82, s33, v82
    v_mul_f32 v83, s33, v83
    v_mul_f32 v84, s33, v84
    v_mul_f32 v85, s33, v85
    v_mul_f32 v86, s33, v86
    v_mul_f32 v87, s33, v87
    v_mul_f32 v88, s33, v88
    v_mul_f32 v89, s33, v89
    v_mul_f32 v90, s33, v90
    v_mul_f32 v91, s33, v91
    v_mul_f32 v92, s33, v92
    v_mul_f32 v93, s33, v93
    v_mul_f32 v94, s33, v94
    v_mul_f32 v95, s33, v95
    v_cvt_pk_bf16_f32 v16, v80, v81
    v_cvt_pk_bf16_f32 v17, v82, v83
    v_cvt_pk_bf16_f32 v18, v84, v85
    v_cvt_pk_bf16_f32 v19, v86, v87
    v_cvt_pk_bf16_f32 v20, v88, v89
    v_cvt_pk_bf16_f32 v21, v90, v91
    v_cvt_pk_bf16_f32 v22, v92, v93
    v_cvt_pk_bf16_f32 v23, v94, v95
    s_add_u32 s37, s36, 0
    buffer_store_dwordx4 v[16:19], v12, s[20:23], s37 offen sc1
    s_add_u32 s38, s36, 65536
    buffer_store_dwordx4 v[20:23], v12, s[20:23], s38 offen sc1
    s_waitcnt vmcnt(6)
    s_mov_b32 s39, 0x100000
P1C_NON:
    v_readfirstlane_b32 s60, v159
    s_sub_u32 s39, s39, 1
    s_cmp_lg_u32 s60, 0
    s_cbranch_scc1 P1C_NOND
    s_cmp_eq_u32 s39, 0
    s_cbranch_scc1 P1C_NOND
    global_load_dword v159, v5, s[50:51] sc1
    s_waitcnt vmcnt(0)
    s_branch P1C_NON
P1C_NOND:
    s_lshl_b32 s36, s28, 1
    s_add_u32 s36, s36, s41
    s_lshl_b32 s36, s36, 6
    s_lshl_b32 s37, s27, 1
    s_add_u32 s36, s36, s37
    s_add_u32 s36, s36, s40
    s_lshl_b32 s36, s36, 2
    s_add_u32 s61, s36, 18874368
    s_cmp_lg_u32 s24, 0
    s_cbranch_scc1 P1C_NONON
    v_mov_b32 v6, 161820
    v_mov_b32 v7, s60
    ds_write_b32 v6, v7
P1C_NONON:
    s_branch KM_A_P1E
KM_A47:
    s_cmp_lg_u32 s24, 5
    s_cbranch_scc1 KM_NON_D
    s_cmp_lg_u32 s2, 0
    s_cbranch_scc1 KM_NON_D
    s_load_dwordx2 s[50:51], s[0:1], 88
    s_memrealtime s[52:53]
    s_waitcnt lgkmcnt(0)
    s_or_b32 s52, s52, 1
    v_mov_b32 v6, s52
    v_mov_b32 v7, 0
    s_mov_b64 exec, 1
    global_store_dword v7, v6, s[50:51] sc1
    s_mov_b64 exec, -1
KM_NON_D:
    s_cmp_lg_u32 s24, 6
    s_cbranch_scc1 KM_CT_D
    s_getpc_b64 s[40:41]
KM_CT_PC:
    s_sub_u32 s40, s40, KM_CT_PC-KM_START
    s_subb_u32 s41, s41, 0
    s_lshl_b32 s42, s26, 4
    v_and_b32 v6, 15, v2
    v_add_u32 v6, s42, v6
    v_lshlrev_b32 v6, 7, v6
    v_min_u32 v6, KM_END-KM_START, v6
    v_mov_b32 v7, s41
    v_add_co_u32 v6, vcc, s40, v6
    s_nop 1
    v_addc_co_u32 v7, vcc, 0, v7, vcc
    global_load_dword v151, v[6:7], off
KM_CT_D:
    s_cmp_lg_u32 s24, 4
    s_cbranch_scc1 KM_A567
    v_lshlrev_b32 v6, 2, v2
    v_add_u32 v6, 161792, v6
    v_mov_b32 v7, 0
    s_mov_b32 s40, 0xffff0f7f
    s_mov_b32 s41, 0xf
    s_mov_b64 exec, s[40:41]
    ds_write_b32 v6, v7
    s_mov_b64 exec, -1
    s_load_dwordx4 s[4:7], s[0:1], 0
    s_lshl_b32 s30, s26, 6
    v_add_u32 v16, s30, v2
    s_mov_b32 s31, 43691
    v_add_u32 v17, 0, v16
    v_mul_lo_u32 v18, v17, s31
    v_lshrrev_b32 v18, 19, v18
    v_mul_u32_u24 v19, 12, v18
    v_sub_u32 v19, v17, v19
    v_mul_u32_u24 v18, 3072, v18
    v_lshrrev_b32 v20, 2, v19
    v_lshl_add_u32 v18, v20, 10, v18
    v_and_b32 v19, 3, v19
    v_lshl_add_u32 v18, v19, 7, v18
    s_and_b32 s30, s25, 1
    s_lshl_b32 s30, s30, 9
    v_add_u32 v24, s30, v18
    v_add_u32 v17, 2048, v16
    v_mul_lo_u32 v18, v17, s31
    v_lshrrev_b32 v18, 19, v18
    v_mul_u32_u24 v19, 12, v18
    v_sub_u32 v19, v17, v19
    v_mul_u32_u24 v18, 3072, v18
    v_lshrrev_b32 v20, 2, v19
    v_lshl_add_u32 v18, v20, 10, v18
    v_and_b32 v19, 3, v19
    v_lshl_add_u32 v18, v19, 7, v18
    s_and_b32 s30, s25, 1
    s_lshl_b32 s30, s30, 9
    v_add_u32 v25, s30, v18
    v_add_u32 v17, 4096, v16
    v_mul_lo_u32 v18, v17, s31
    v_lshrrev_b32 v18, 19, v18
    v_mul_u32_u24 v19, 12, v18
    v_sub_u32 v19, v17, v19
    v_mul_u32_u24 v18, 3072, v18
    v_lshrrev_b32 v20, 2, v19
    v_lshl_add_u32 v18, v20, 10, v18
    v_and_b32 v19, 3, v19
    v_lshl_add_u32 v18, v19, 7, v18
    s_and_b32 s30, s25, 1
    s_lshl_b32 s30, s30, 9
    v_add_u32 v26, s30, v18
    v_add_u32 v17, 0, v16
    v_lshrrev_b32 v18, 9, v17
    v_and_b32 v19, 511, v17
    v_lshlrev_b32 v19, 10, v19
    v_lshl_add_u32 v19, v18, 7, v19
    s_lshr_b32 s30, s25, 1
    s_lshl_b32 s30, s30, 19
    v_add_u32 v28, s30, v19
    v_add_u32 v17, 2048, v16
    v_lshrrev_b32 v18, 9, v17
    v_and_b32 v19, 511, v17
    v_lshlrev_b32 v19, 10, v19
    v_lshl_add_u32 v19, v18, 7, v19
    s_lshr_b32 s30, s25, 1
    s_lshl_b32 s30, s30, 19
    v_add_u32 v29, s30, v19
    s_waitcnt lgkmcnt(0)
    global_load_dword v150, v24, s[6:7]
    global_load_dword v151, v28, s[4:5]
    global_load_dword v152, v25, s[6:7]
    global_load_dword v153, v29, s[4:5]
    global_load_dword v154, v26, s[6:7]
    s_waitcnt lgkmcnt(0)
    s_barrier
    s_barrier
    s_barrier
    s_barrier
    s_barrier
    s_barrier
    s_barrier
    s_barrier
    s_barrier
    s_barrier
    s_barrier
    s_barrier
    s_barrier
    s_barrier
    s_barrier
    s_barrier
    s_barrier
    s_branch KM_A_P1E
KM_A567:
    s_barrier
    s_barrier
    s_barrier
    s_barrier
    s_barrier
    s_barrier
    s_barrier
    s_barrier
    s_barrier
    s_barrier
    s_barrier
    s_barrier
    s_barrier
    s_barrier
    s_barrier
    s_barrier
    s_barrier
KM_A_P1E:
    s_lshl_b32 s28, s25, 6
    s_lshl_b32 s29, s26, 1
    s_add_u32 s28, s28, s29
    s_bfe_u32 s30, s24, 0x10001
    s_and_b32 s31, s24, 1
    s_lshr_b32 s35, s24, 2
    s_add_u32 s32, s28, s30
    s_cmp_lt_u32 s24, 4
    s_cbranch_scc1 KG_PW
    s_waitcnt vmcnt(0)
    s_branch KG_PD
KG_PW:
    s_waitcnt vmcnt(7)
KG_PD:
    v_lshlrev_b32 v10, 16, v160
    v_lshlrev_b32 v11, 16, v161
    v_lshlrev_b32 v12, 16, v162
    v_lshlrev_b32 v13, 16, v163
    v_lshlrev_b32 v14, 16, v164
    v_mul_f32 v14, 0x3fb8aa3b, v14
    v_mul_f32 v10, 0x3fb8aa3b, v10
    v_exp_f32 v14, v14
    v_exp_f32 v10, v10
    s_nop 0
    v_cvt_pk_bf16_f32 v14, v14, v14
    v_cvt_pk_bf16_f32 v10, v10, v10
    v_lshlrev_b32 v14, 16, v14
    v_lshlrev_b32 v10, 16, v10
    v_mul_f32 v10, v10, v14
    v_mul_f32 v11, v11, v14
    v_mul_f32 v10, 0xbfb8aa3b, v10
    v_mul_f32 v11, 0x3e22f983, v11
    s_lshl_b32 s36, s30, 16
    s_add_u32 s36, s36, 7168
    s_add_u32 s37, s36, 32768
    s_lshl_b32 s38, s31, 8
    v_lshlrev_b32 v15, 2, v2
    v_add_u32 v15, s38, v15
    s_cmp_eq_u32 s35, 0
    s_cbranch_scc0 KG_XP
    v_add_u32 v15, s37, v15
    v_exp_f32 v4, v10
    v_fract_f32 v5, v11
    s_nop 0
    v_cos_f32 v16, v5
    v_sin_f32 v17, v5
    s_nop 0
    v_mul_f32 v16, v16, v4
    v_mul_f32 v17, v17, v4
    v_mul_f32 v6, 0x44800000, v10
    v_mul_f32 v7, 0x44800000, v11
    v_exp_f32 v6, v6
    v_fract_f32 v7, v7
    s_nop 0
    v_cos_f32 v22, v7
    v_sin_f32 v23, v7
    s_nop 0
    v_mul_f32 v22, v22, v6
    v_mul_f32 v23, v23, v6
    v_pk_mul_f32 v[18:19], v[16:17], v[16:17] op_sel:[0,0] op_sel_hi:[0,1]
    v_pk_fma_f32 v[18:19], v[16:17], v[16:17], v[18:19] op_sel:[1,1,0] op_sel_hi:[1,0,1] neg_lo:[1,0,0]
    v_mov_b32 v28, 1.0
    v_mov_b32 v29, 0
    v_mov_b32 v30, v16
    v_mov_b32 v31, v17
    v_mov_b32 v32, v18
    v_mov_b32 v33, v19
    v_pk_mul_f32 v[34:35], v[18:19], v[16:17] op_sel:[0,0] op_sel_hi:[0,1]
    v_pk_mul_f32 v[20:21], v[18:19], v[18:19] op_sel:[0,0] op_sel_hi:[0,1]
    v_pk_fma_f32 v[34:35], v[18:19], v[16:17], v[34:35] op_sel:[1,1,0] op_sel_hi:[1,0,1] neg_lo:[1,0,0]
    v_pk_fma_f32 v[20:21], v[18:19], v[18:19], v[20:21] op_sel:[1,1,0] op_sel_hi:[1,0,1] neg_lo:[1,0,0]
    v_pk_mul_f32 v[44:45], v[28:29], v[20:21] op_sel:[0,0] op_sel_hi:[0,1]
    v_pk_mul_f32 v[46:47], v[30:31], v[20:21] op_sel:[0,0] op_sel_hi:[0,1]
    v_pk_mul_f32 v[48:49], v[32:33], v[20:21] op_sel:[0,0] op_sel_hi:[0,1]
    v_pk_mul_f32 v[50:51], v[34:35], v[20:21] op_sel:[0,0] op_sel_hi:[0,1]
    v_cvt_pk_bf16_f32 v60, v28, -v29
    ds_write_b32 v15, v60 offset:0
    v_cvt_pk_bf16_f32 v61, v30, -v31
    ds_write_b32 v15, v61 offset:528
    v_cvt_pk_bf16_f32 v62, v32, -v33
    ds_write_b32 v15, v62 offset:1056
    v_cvt_pk_bf16_f32 v63, v34, -v35
    ds_write_b32 v15, v63 offset:1584
    v_pk_fma_f32 v[44:45], v[28:29], v[20:21], v[44:45] op_sel:[1,1,0] op_sel_hi:[1,0,1] neg_lo:[1,0,0]
    v_pk_fma_f32 v[46:47], v[30:31], v[20:21], v[46:47] op_sel:[1,1,0] op_sel_hi:[1,0,1] neg_lo:[1,0,0]
    v_pk_fma_f32 v[48:49], v[32:33], v[20:21], v[48:49] op_sel:[1,1,0] op_sel_hi:[1,0,1] neg_lo:[1,0,0]
    v_pk_fma_f32 v[50:51], v[34:35], v[20:21], v[50:51] op_sel:[1,1,0] op_sel_hi:[1,0,1] neg_lo:[1,0,0]
    v_pk_mul_f32 v[70:71], v[44:45], v[20:21] op_sel:[0,0] op_sel_hi:[0,1]
    v_pk_mul_f32 v[30:31], v[46:47], v[20:21] op_sel:[0,0] op_sel_hi:[0,1]
    v_pk_mul_f32 v[32:33], v[48:49], v[20:21] op_sel:[0,0] op_sel_hi:[0,1]
    v_pk_mul_f32 v[34:35], v[50:51], v[20:21] op_sel:[0,0] op_sel_hi:[0,1]
    v_cvt_pk_bf16_f32 v64, v44, -v45
    ds_write_b32 v15, v64 offset:2112
    v_cvt_pk_bf16_f32 v65, v46, -v47
    ds_write_b32 v15, v65 offset:2640
    v_cvt_pk_bf16_f32 v66, v48, -v49
    ds_write_b32 v15, v66 offset:3168
    v_cvt_pk_bf16_f32 v67, v50, -v51
    ds_write_b32 v15, v67 offset:3696
    v_pk_fma_f32 v[70:71], v[44:45], v[20:21], v[70:71] op_sel:[1,1,0] op_sel_hi:[1,0,1] neg_lo:[1,0,0]
    v_pk_fma_f32 v[30:31], v[46:47], v[20:21], v[30:31] op_sel:[1,1,0] op_sel_hi:[1,0,1] neg_lo:[1,0,0]
    v_pk_fma_f32 v[32:33], v[48:49], v[20:21], v[32:33] op_sel:[1,1,0] op_sel_hi:[1,0,1] neg_lo:[1,0,0]
    v_pk_fma_f32 v[34:35], v[50:51], v[20:21], v[34:35] op_sel:[1,1,0] op_sel_hi:[1,0,1] neg_lo:[1,0,0]
    v_pk_mul_f32 v[28:29], v[70:71], v[20:21] op_sel:[0,0] op_sel_hi:[0,1]
    v_pk_mul_f32 v[46:47], v[30:31], v[20:21] op_sel:[0,0] op_sel_hi:[0,1]
    v_pk_mul_f32 v[48:49], v[32:33], v[20:21] op_sel:[0,0] op_sel_hi:[0,1]
    v_pk_mul_f32 v[50:51], v[34:35], v[20:21] op_sel:[0,0] op_sel_hi:[0,1]
    v_cvt_pk_bf16_f32 v60, v70, -v71
    ds_write_b32 v15, v60 offset:4224
    v_cvt_pk_bf16_f32 v61, v30, -v31
    ds_write_b32 v15, v61 offset:4752
    v_cvt_pk_bf16_f32 v62, v32, -v33
    ds_write_b32 v15, v62 offset:5280
    v_cvt_pk_bf16_f32 v63, v34, -v35
    ds_write_b32 v15, v63 offset:5808
    v_pk_fma_f32 v[28:29], v[70:71], v[20:21], v[28:29] op_sel:[1,1,0] op_sel_hi:[1,0,1] neg_lo:[1,0,0]
    v_pk_fma_f32 v[46:47], v[30:31], v[20:21], v[46:47] op_sel:[1,1,0] op_sel_hi:[1,0,1] neg_lo:[1,0,0]
    v_pk_fma_f32 v[48:49], v[32:33], v[20:21], v[48:49] op_sel:[1,1,0] op_sel_hi:[1,0,1] neg_lo:[1,0,0]
    v_pk_fma_f32 v[50:51], v[34:35], v[20:21], v[50:51] op_sel:[1,1,0] op_sel_hi:[1,0,1] neg_lo:[1,0,0]
    v_pk_mul_f32 v[72:73], v[28:29], v[20:21] op_sel:[0,0] op_sel_hi:[0,1]
    v_pk_mul_f32 v[30:31], v[46:47], v[20:21] op_sel:[0,0] op_sel_hi:[0,1]
    v_pk_mul_f32 v[32:33], v[48:49], v[20:21] op_sel:[0,0] op_sel_hi:[0,1]
    v_pk_mul_f32 v[34:35], v[50:51], v[20:21] op_sel:[0,0] op_sel_hi:[0,1]
    v_cvt_pk_bf16_f32 v64, v28, -v29
    ds_write_b32 v15, v64 offset:6336
    v_cvt_pk_bf16_f32 v65, v46, -v47
    ds_write_b32 v15, v65 offset:6864
    v_cvt_pk_bf16_f32 v66, v48, -v49
    ds_write_b32 v15, v66 offset:7392
    v_cvt_pk_bf16_f32 v67, v50, -v51
    ds_write_b32 v15, v67 offset:7920
    v_pk_fma_f32 v[72:73], v[28:29], v[20:21], v[72:73] op_sel:[1,1,0] op_sel_hi:[1,0,1] neg_lo:[1,0,0]
    v_pk_fma_f32 v[30:31], v[46:47], v[20:21], v[30:31] op_sel:[1,1,0] op_sel_hi:[1,0,1] neg_lo:[1,0,0]
    v_pk_fma_f32 v[32:33], v[48:49], v[20:21], v[32:33] op_sel:[1,1,0] op_sel_hi:[1,0,1] neg_lo:[1,0,0]
    v_pk_fma_f32 v[34:35], v[50:51], v[20:21], v[34:35] op_sel:[1,1,0] op_sel_hi:[1,0,1] neg_lo:[1,0,0]
    v_pk_mul_f32 v[44:45], v[72:73], v[20:21] op_sel:[0,0] op_sel_hi:[0,1]
    v_pk_mul_f32 v[46:47], v[30:31], v[20:21] op_sel:[0,0] op_sel_hi:[0,1]
    v_pk_mul_f32 v[48:49], v[32:33], v[20:21] op_sel:[0,0] op_sel_hi:[0,1]
    v_pk_mul_f32 v[50:51], v[34:35], v[20:21] op_sel:[0,0] op_sel_hi:[0,1]
    v_cvt_pk_bf16_f32 v60, v72, -v73
    ds_write_b32 v15, v60 offset:8448
    v_cvt_pk_bf16_f32 v61, v30, -v31
    ds_write_b32 v15, v61 offset:8976
    v_cvt_pk_bf16_f32 v62, v32, -v33
    ds_write_b32 v15, v62 offset:9504
    v_cvt_pk_bf16_f32 v63, v34, -v35
    ds_write_b32 v15, v63 offset:10032
    v_pk_fma_f32 v[44:45], v[72:73], v[20:21], v[44:45] op_sel:[1,1,0] op_sel_hi:[1,0,1] neg_lo:[1,0,0]
    v_pk_fma_f32 v[46:47], v[30:31], v[20:21], v[46:47] op_sel:[1,1,0] op_sel_hi:[1,0,1] neg_lo:[1,0,0]
    v_pk_fma_f32 v[48:49], v[32:33], v[20:21], v[48:49] op_sel:[1,1,0] op_sel_hi:[1,0,1] neg_lo:[1,0,0]
    v_pk_fma_f32 v[50:51], v[34:35], v[20:21], v[50:51] op_sel:[1,1,0] op_sel_hi:[1,0,1] neg_lo:[1,0,0]
    v_pk_mul_f32 v[74:75], v[44:45], v[20:21] op_sel:[0,0] op_sel_hi:[0,1]
    v_pk_mul_f32 v[30:31], v[46:47], v[20:21] op_sel:[0,0] op_sel_hi:[0,1]
    v_pk_mul_f32 v[32:33], v[48:49], v[20:21] op_sel:[0,0] op_sel_hi:[0,1]
    v_pk_mul_f32 v[34:35], v[50:51], v[20:21] op_sel:[0,0] op_sel_hi:[0,1]
    v_cvt_pk_bf16_f32 v64, v44, -v45
    ds_write_b32 v15, v64 offset:10560
    v_cvt_pk_bf16_f32 v65, v46, -v47
    ds_write_b32 v15, v65 offset:11088
    v_cvt_pk_bf16_f32 v66, v48, -v49
    ds_write_b32 v15, v66 offset:11616
    v_cvt_pk_bf16_f32 v67, v50, -v51
    ds_write_b32 v15, v67 offset:12144
    v_pk_fma_f32 v[74:75], v[44:45], v[20:21], v[74:75] op_sel:[1,1,0] op_sel_hi:[1,0,1] neg_lo:[1,0,0]
    v_pk_fma_f32 v[30:31], v[46:47], v[20:21], v[30:31] op_sel:[1,1,0] op_sel_hi:[1,0,1] neg_lo:[1,0,0]
    v_pk_fma_f32 v[32:33], v[48:49], v[20:21], v[32:33] op_sel:[1,1,0] op_sel_hi:[1,0,1] neg_lo:[1,0,0]
    v_pk_fma_f32 v[34:35], v[50:51], v[20:21], v[34:35] op_sel:[1,1,0] op_sel_hi:[1,0,1] neg_lo:[1,0,0]
    v_pk_mul_f32 v[28:29], v[74:75], v[20:21] op_sel:[0,0] op_sel_hi:[0,1]
    v_pk_mul_f32 v[46:47], v[30:31], v[20:21] op_sel:[0,0] op_sel_hi:[0,1]
    v_pk_mul_f32 v[48:49], v[32:33], v[20:21] op_sel:[0,0] op_sel_hi:[0,1]
    v_pk_mul_f32 v[50:51], v[34:35], v[20:21] op_sel:[0,0] op_sel_hi:[0,1]
    v_cvt_pk_bf16_f32 v60, v74, -v75
    ds_write_b32 v15, v60 offset:12672
    v_cvt_pk_bf16_f32 v61, v30, -v31
    ds_write_b32 v15, v61 offset:13200
    v_cvt_pk_bf16_f32 v62, v32, -v33
    ds_write_b32 v15, v62 offset:13728
    v_cvt_pk_bf16_f32 v63, v34, -v35
    ds_write_b32 v15, v63 offset:14256
    v_pk_fma_f32 v[28:29], v[74:75], v[20:21], v[28:29] op_sel:[1,1,0] op_sel_hi:[1,0,1] neg_lo:[1,0,0]
    v_pk_fma_f32 v[46:47], v[30:31], v[20:21], v[46:47] op_sel:[1,1,0] op_sel_hi:[1,0,1] neg_lo:[1,0,0]
    v_pk_fma_f32 v[48:49], v[32:33], v[20:21], v[48:49] op_sel:[1,1,0] op_sel_hi:[1,0,1] neg_lo:[1,0,0]
    v_pk_fma_f32 v[50:51], v[34:35], v[20:21], v[50:51] op_sel:[1,1,0] op_sel_hi:[1,0,1] neg_lo:[1,0,0]
    v_pk_mul_f32 v[76:77], v[28:29], v[20:21] op_sel:[0,0] op_sel_hi:[0,1]
    v_cvt_pk_bf16_f32 v64, v28, -v29
    ds_write_b32 v15, v64 offset:14784
    v_cvt_pk_bf16_f32 v65, v46, -v47
    ds_write_b32 v15, v65 offset:15312
    v_cvt_pk_bf16_f32 v66, v48, -v49
    ds_write_b32 v15, v66 offset:15840
    v_cvt_pk_bf16_f32 v67, v50, -v51
    ds_write_b32 v15, v67 offset:16368
    v_pk_fma_f32 v[76:77], v[28:29], v[20:21], v[76:77] op_sel:[1,1,0] op_sel_hi:[1,0,1] neg_lo:[1,0,0]
    v_cvt_pk_bf16_f32 v60, v76, -v77
    ds_write_b32 v15, v60 offset:16896
    v_pk_mul_f32 v[52:53], v[70:71], v[22:23] op_sel:[0,0] op_sel_hi:[0,1]
    v_pk_mul_f32 v[54:55], v[72:73], v[22:23] op_sel:[0,0] op_sel_hi:[0,1]
    v_pk_mul_f32 v[56:57], v[74:75], v[22:23] op_sel:[0,0] op_sel_hi:[0,1]
    v_pk_mul_f32 v[58:59], v[76:77], v[22:23] op_sel:[0,0] op_sel_hi:[0,1]
    v_cvt_pk_bf16_f32 v61, v22, -v23
    ds_write_b32 v15, v61 offset:17424
    v_pk_fma_f32 v[52:53], v[70:71], v[22:23], v[52:53] op_sel:[1,1,0] op_sel_hi:[1,0,1] neg_lo:[1,0,0]
    v_pk_fma_f32 v[54:55], v[72:73], v[22:23], v[54:55] op_sel:[1,1,0] op_sel_hi:[1,0,1] neg_lo:[1,0,0]
    v_pk_fma_f32 v[56:57], v[74:75], v[22:23], v[56:57] op_sel:[1,1,0] op_sel_hi:[1,0,1] neg_lo:[1,0,0]
    v_pk_fma_f32 v[58:59], v[76:77], v[22:23], v[58:59] op_sel:[1,1,0] op_sel_hi:[1,0,1] neg_lo:[1,0,0]
    v_cvt_pk_bf16_f32 v62, v52, -v53
    ds_write_b32 v15, v62 offset:17952
    v_cvt_pk_bf16_f32 v63, v54, -v55
    ds_write_b32 v15, v63 offset:18480
    v_cvt_pk_bf16_f32 v64, v56, -v57
    ds_write_b32 v15, v64 offset:19008
    v_cvt_pk_bf16_f32 v65, v58, -v59
    ds_write_b32 v15, v65 offset:19536
    s_branch KG_TD
KG_XP:
    v_add_u32 v15, s36, v15
    v_lshlrev_b32 v12, 16, v162
    v_mul_f32 v12, v12, v14
    v_mul_f32 v13, v13, v14
    v_add_f32 v28, v12, v12
    v_add_f32 v29, v13, v13
    v_mul_f32 v4, 0x42000000, v10
    v_mul_f32 v5, 0x42000000, v11
    v_exp_f32 v4, v4
    v_fract_f32 v5, v5
    s_nop 0
    v_cos_f32 v16, v5
    v_sin_f32 v17, v5
    s_nop 0
    v_mul_f32 v16, v16, v4
    v_mul_f32 v17, v17, v4
    v_pk_mul_f32 v[18:19], v[16:17], v[16:17] op_sel:[0,0] op_sel_hi:[0,1]
    v_pk_mul_f32 v[30:31], v[28:29], v[16:17] op_sel:[0,0] op_sel_hi:[0,1]
    v_pk_fma_f32 v[18:19], v[16:17], v[16:17], v[18:19] op_sel:[1,1,0] op_sel_hi:[1,0,1] neg_lo:[1,0,0]
    v_pk_fma_f32 v[30:31], v[28:29], v[16:17], v[30:31] op_sel:[1,1,0] op_sel_hi:[1,0,1] neg_lo:[1,0,0]
    v_pk_mul_f32 v[32:33], v[28:29], v[18:19] op_sel:[0,0] op_sel_hi:[0,1]
    v_pk_mul_f32 v[34:35], v[30:31], v[18:19] op_sel:[0,0] op_sel_hi:[0,1]
    v_pk_mul_f32 v[20:21], v[18:19], v[18:19] op_sel:[0,0] op_sel_hi:[0,1]
    v_pk_fma_f32 v[32:33], v[28:29], v[18:19], v[32:33] op_sel:[1,1,0] op_sel_hi:[1,0,1] neg_lo:[1,0,0]
    v_pk_fma_f32 v[34:35], v[30:31], v[18:19], v[34:35] op_sel:[1,1,0] op_sel_hi:[1,0,1] neg_lo:[1,0,0]
    v_pk_fma_f32 v[20:21], v[18:19], v[18:19], v[20:21] op_sel:[1,1,0] op_sel_hi:[1,0,1] neg_lo:[1,0,0]
    v_pk_mul_f32 v[44:45], v[28:29], v[20:21] op_sel:[0,0] op_sel_hi:[0,1]
    v_pk_mul_f32 v[46:47], v[30:31], v[20:21] op_sel:[0,0] op_sel_hi:[0,1]
    v_pk_mul_f32 v[48:49], v[32:33], v[20:21] op_sel:[0,0] op_sel_hi:[0,1]
    v_pk_mul_f32 v[50:51], v[34:35], v[20:21] op_sel:[0,0] op_sel_hi:[0,1]
    v_cvt_pk_bf16_f32 v60, v28, v29
    ds_write_b32 v15, v60 offset:0
    v_cvt_pk_bf16_f32 v61, v30, v31
    ds_write_b32 v15, v61 offset:528
    v_cvt_pk_bf16_f32 v62, v32, v33
    ds_write_b32 v15, v62 offset:1056
    v_cvt_pk_bf16_f32 v63, v34, v35
    ds_write_b32 v15, v63 offset:1584
    v_pk_fma_f32 v[44:45], v[28:29], v[20:21], v[44:45] op_sel:[1,1,0] op_sel_hi:[1,0,1] neg_lo:[1,0,0]
    v_pk_fma_f32 v[46:47], v[30:31], v[20:21], v[46:47] op_sel:[1,1,0] op_sel_hi:[1,0,1] neg_lo:[1,0,0]
    v_pk_fma_f32 v[48:49], v[32:33], v[20:21], v[48:49] op_sel:[1,1,0] op_sel_hi:[1,0,1] neg_lo:[1,0,0]
    v_pk_fma_f32 v[50:51], v[34:35], v[20:21], v[50:51] op_sel:[1,1,0] op_sel_hi:[1,0,1] neg_lo:[1,0,0]
    v_pk_mul_f32 v[28:29], v[44:45], v[20:21] op_sel:[0,0] op_sel_hi:[0,1]
    v_pk_mul_f32 v[30:31], v[46:47], v[20:21] op_sel:[0,0] op_sel_hi:[0,1]
    v_pk_mul_f32 v[32:33], v[48:49], v[20:21] op_sel:[0,0] op_sel_hi:[0,1]
    v_pk_mul_f32 v[34:35], v[50:51], v[20:21] op_sel:[0,0] op_sel_hi:[0,1]
    v_cvt_pk_bf16_f32 v64, v44, v45
    ds_write_b32 v15, v64 offset:2112
    v_cvt_pk_bf16_f32 v65, v46, v47
    ds_write_b32 v15, v65 offset:2640
    v_cvt_pk_bf16_f32 v66, v48, v49
    ds_write_b32 v15, v66 offset:3168
    v_cvt_pk_bf16_f32 v67, v50, v51
    ds_write_b32 v15, v67 offset:3696
    v_pk_fma_f32 v[28:29], v[44:45], v[20:21], v[28:29] op_sel:[1,1,0] op_sel_hi:[1,0,1] neg_lo:[1,0,0]
    v_pk_fma_f32 v[30:31], v[46:47], v[20:21], v[30:31] op_sel:[1,1,0] op_sel_hi:[1,0,1] neg_lo:[1,0,0]
    v_pk_fma_f32 v[32:33], v[48:49], v[20:21], v[32:33] op_sel:[1,1,0] op_sel_hi:[1,0,1] neg_lo:[1,0,0]
    v_pk_fma_f32 v[34:35], v[50:51], v[20:21], v[34:35] op_sel:[1,1,0] op_sel_hi:[1,0,1] neg_lo:[1,0,0]
    v_pk_mul_f32 v[44:45], v[28:29], v[20:21] op_sel:[0,0] op_sel_hi:[0,1]
    v_pk_mul_f32 v[46:47], v[30:31], v[20:21] op_sel:[0,0] op_sel_hi:[0,1]
    v_pk_mul_f32 v[48:49], v[32:33], v[20:21] op_sel:[0,0] op_sel_hi:[0,1]
    v_pk_mul_f32 v[50:51], v[34:35], v[20:21] op_sel:[0,0] op_sel_hi:[0,1]
    v_cvt_pk_bf16_f32 v60, v28, v29
    ds_write_b32 v15, v60 offset:4224
    v_cvt_pk_bf16_f32 v61, v30, v31
    ds_write_b32 v15, v61 offset:4752
    v_cvt_pk_bf16_f32 v62, v32, v33
    ds_write_b32 v15, v62 offset:5280
    v_cvt_pk_bf16_f32 v63, v34, v35
    ds_write_b32 v15, v63 offset:5808
    v_pk_fma_f32 v[44:45], v[28:29], v[20:21], v[44:45] op_sel:[1,1,0] op_sel_hi:[1,0,1] neg_lo:[1,0,0]
    v_pk_fma_f32 v[46:47], v[30:31], v[20:21], v[46:47] op_sel:[1,1,0] op_sel_hi:[1,0,1] neg_lo:[1,0,0]
    v_pk_fma_f32 v[48:49], v[32:33], v[20:21], v[48:49] op_sel:[1,1,0] op_sel_hi:[1,0,1] neg_lo:[1,0,0]
    v_pk_fma_f32 v[50:51], v[34:35], v[20:21], v[50:51] op_sel:[1,1,0] op_sel_hi:[1,0,1] neg_lo:[1,0,0]
    v_pk_mul_f32 v[28:29], v[44:45], v[20:21] op_sel:[0,0] op_sel_hi:[0,1]
    v_pk_mul_f32 v[30:31], v[46:47], v[20:21] op_sel:[0,0] op_sel_hi:[0,1]
    v_pk_mul_f32 v[32:33], v[48:49], v[20:21] op_sel:[0,0] op_sel_hi:[0,1]
    v_pk_mul_f32 v[34:35], v[50:51], v[20:21] op_sel:[0,0] op_sel_hi:[0,1]
    v_cvt_pk_bf16_f32 v64, v44, v45
    ds_write_b32 v15, v64 offset:6336
    v_cvt_pk_bf16_f32 v65, v46, v47
    ds_write_b32 v15, v65 offset:6864
    v_cvt_pk_bf16_f32 v66, v48, v49
    ds_write_b32 v15, v66 offset:7392
    v_cvt_pk_bf16_f32 v67, v50, v51
    ds_write_b32 v15, v67 offset:7920
    v_pk_fma_f32 v[28:29], v[44:45], v[20:21], v[28:29] op_sel:[1,1,0] op_sel_hi:[1,0,1] neg_lo:[1,0,0]
    v_pk_fma_f32 v[30:31], v[46:47], v[20:21], v[30:31] op_sel:[1,1,0] op_sel_hi:[1,0,1] neg_lo:[1,0,0]
    v_pk_fma_f32 v[32:33], v[48:49], v[20:21], v[32:33] op_sel:[1,1,0] op_sel_hi:[1,0,1] neg_lo:[1,0,0]
    v_pk_fma_f32 v[34:35], v[50:51], v[20:21], v[34:35] op_sel:[1,1,0] op_sel_hi:[1,0,1] neg_lo:[1,0,0]
    v_pk_mul_f32 v[44:45], v[28:29], v[20:21] op_sel:[0,0] op_sel_hi:[0,1]
    v_pk_mul_f32 v[46:47], v[30:31], v[20:21] op_sel:[0,0] op_sel_hi:[0,1]
    v_pk_mul_f32 v[48:49], v[32:33], v[20:21] op_sel:[0,0] op_sel_hi:[0,1]
    v_pk_mul_f32 v[50:51], v[34:35], v[20:21] op_sel:[0,0] op_sel_hi:[0,1]
    v_cvt_pk_bf16_f32 v60, v28, v29
    ds_write_b32 v15, v60 offset:8448
    v_cvt_pk_bf16_f32 v61, v30, v31
    ds_write_b32 v15, v61 offset:8976
    v_cvt_pk_bf16_f32 v62, v32, v33
    ds_write_b32 v15, v62 offset:9504
    v_cvt_pk_bf16_f32 v63, v34, v35
    ds_write_b32 v15, v63 offset:10032
    v_pk_fma_f32 v[44:45], v[28:29], v[20:21], v[44:45] op_sel:[1,1,0] op_sel_hi:[1,0,1] neg_lo:[1,0,0]
    v_pk_fma_f32 v[46:47], v[30:31], v[20:21], v[46:47] op_sel:[1,1,0] op_sel_hi:[1,0,1] neg_lo:[1,0,0]
    v_pk_fma_f32 v[48:49], v[32:33], v[20:21], v[48:49] op_sel:[1,1,0] op_sel_hi:[1,0,1] neg_lo:[1,0,0]
    v_pk_fma_f32 v[50:51], v[34:35], v[20:21], v[50:51] op_sel:[1,1,0] op_sel_hi:[1,0,1] neg_lo:[1,0,0]
    v_pk_mul_f32 v[28:29], v[44:45], v[20:21] op_sel:[0,0] op_sel_hi:[0,1]
    v_pk_mul_f32 v[30:31], v[46:47], v[20:21] op_sel:[0,0] op_sel_hi:[0,1]
    v_pk_mul_f32 v[32:33], v[48:49], v[20:21] op_sel:[0,0] op_sel_hi:[0,1]
    v_pk_mul_f32 v[34:35], v[50:51], v[20:21] op_sel:[0,0] op_sel_hi:[0,1]
    v_cvt_pk_bf16_f32 v64, v44, v45
    ds_write_b32 v15, v64 offset:10560
    v_cvt_pk_bf16_f32 v65, v46, v47
    ds_write_b32 v15, v65 offset:11088
    v_cvt_pk_bf16_f32 v66, v48, v49
    ds_write_b32 v15, v66 offset:11616
    v_cvt_pk_bf16_f32 v67, v50, v51
    ds_write_b32 v15, v67 offset:12144
    v_pk_fma_f32 v[28:29], v[44:45], v[20:21], v[28:29] op_sel:[1,1,0] op_sel_hi:[1,0,1] neg_lo:[1,0,0]
    v_pk_fma_f32 v[30:31], v[46:47], v[20:21], v[30:31] op_sel:[1,1,0] op_sel_hi:[1,0,1] neg_lo:[1,0,0]
    v_pk_fma_f32 v[32:33], v[48:49], v[20:21], v[32:33] op_sel:[1,1,0] op_sel_hi:[1,0,1] neg_lo:[1,0,0]
    v_pk_fma_f32 v[34:35], v[50:51], v[20:21], v[34:35] op_sel:[1,1,0] op_sel_hi:[1,0,1] neg_lo:[1,0,0]
    v_pk_mul_f32 v[44:45], v[28:29], v[20:21] op_sel:[0,0] op_sel_hi:[0,1]
    v_pk_mul_f32 v[46:47], v[30:31], v[20:21] op_sel:[0,0] op_sel_hi:[0,1]
    v_pk_mul_f32 v[48:49], v[32:33], v[20:21] op_sel:[0,0] op_sel_hi:[0,1]
    v_pk_mul_f32 v[50:51], v[34:35], v[20:21] op_sel:[0,0] op_sel_hi:[0,1]
    v_cvt_pk_bf16_f32 v60, v28, v29
    ds_write_b32 v15, v60 offset:12672
    v_cvt_pk_bf16_f32 v61, v30, v31
    ds_write_b32 v15, v61 offset:13200
    v_cvt_pk_bf16_f32 v62, v32, v33
    ds_write_b32 v15, v62 offset:13728
    v_cvt_pk_bf16_f32 v63, v34, v35
    ds_write_b32 v15, v63 offset:14256
    v_pk_fma_f32 v[44:45], v[28:29], v[20:21], v[44:45] op_sel:[1,1,0] op_sel_hi:[1,0,1] neg_lo:[1,0,0]
    v_pk_fma_f32 v[46:47], v[30:31], v[20:21], v[46:47] op_sel:[1,1,0] op_sel_hi:[1,0,1] neg_lo:[1,0,0]
    v_pk_fma_f32 v[48:49], v[32:33], v[20:21], v[48:49] op_sel:[1,1,0] op_sel_hi:[1,0,1] neg_lo:[1,0,0]
    v_pk_fma_f32 v[50:51], v[34:35], v[20:21], v[50:51] op_sel:[1,1,0] op_sel_hi:[1,0,1] neg_lo:[1,0,0]
    v_cvt_pk_bf16_f32 v64, v44, v45
    ds_write_b32 v15, v64 offset:14784
    v_cvt_pk_bf16_f32 v65, v46, v47
    ds_write_b32 v15, v65 offset:15312
    v_cvt_pk_bf16_f32 v66, v48, v49
    ds_write_b32 v15, v66 offset:15840
    v_cvt_pk_bf16_f32 v67, v50, v51
    ds_write_b32 v15, v67 offset:16368
KG_TD:
    s_lshl_b32 s39, s35, 1
    s_add_u32 s39, s39, s31
    v_and_b32 v5, 31, v2
    v_lshrrev_b32 v6, 5, v2
    v_lshlrev_b32 v7, 4, v6
    v_mul_u32_u24 v8, 528, v5
    v_add_u32 v16, v7, v8
    v_add_u32 v16, s36, v16
    v_cvt_f32_u32 v9, v5
    s_mov_b32 s40, 0
    s_cmp_eq_u32 s39, 1
    s_cselect_b32 s40, 0x43800000, s40
    s_cmp_eq_u32 s39, 2
    s_cselect_b32 s40, 0x44000000, s40
    s_cmp_eq_u32 s39, 3
    s_cselect_b32 s40, 0x44800000, s40
    v_add_f32 v17, s40, v9
    v_cvt_pk_bf16_f32 v17, v17, v17
    v_lshlrev_b32 v17, 16, v17
    v_subrev_f32 v17, s40, v17
    v_cvt_u32_f32 v17, v17
    v_lshrrev_b32 v18, 3, v17
    v_add_u32 v18, 33, v18
    s_cmp_eq_u32 s39, 3
    s_cselect_b64 vcc, -1, 0
    v_cndmask_b32 v17, v17, v18, vcc
    v_mul_u32_u24 v17, 528, v17
    v_add_u32 v17, v7, v17
    v_add_u32 v17, s37, v17
    s_waitcnt lgkmcnt(0)
    v_mov_b32 v18, 161796
    v_mov_b32 v19, 1
    s_mov_b64 exec, 1
    ds_add_u32 v18, v19
    s_mov_b64 exec, -1
    s_cmp_ge_u32 s24, 4
    s_cbranch_scc1 KG_NOST
    s_waitcnt vmcnt(0)
    v_mov_b32 v20, s61
    v_mov_b32 v21, s60
    s_mov_b64 exec, 1
    global_store_dword v20, v21, s[62:63] sc1
    s_mov_b64 exec, -1
    s_waitcnt lgkmcnt(0)
    v_mov_b32 v20, 161808
    v_mov_b32 v21, 1
    s_mov_b64 exec, 1
    ds_add_u32 v20, v21
    s_mov_b64 exec, -1
KG_NOST:
    v_mov_b32 v18, 161796
    s_mov_b32 s42, 0x400000
LW_S1:
    ds_read_b32 v19, v18
    s_sub_u32 s42, s42, 1
    s_waitcnt lgkmcnt(0)
    v_readfirstlane_b32 s41, v19
    s_cmp_eq_u32 s42, 0
    s_cbranch_scc1 LWD_S1
    s_cmp_ge_u32 s41, 8
    s_cbranch_scc1 LWD_S1
    s_sleep 1
    s_branch LW_S1
LWD_S1:
    ds_read_b128 v[20:23], v16 offset:0
    ds_read_b128 v[24:27], v17 offset:0
    ds_read_b128 v[28:31], v16 offset:32
    ds_read_b128 v[32:35], v17 offset:32
    ds_read_b128 v[36:39], v16 offset:64
    ds_read_b128 v[40:43], v17 offset:64
    ds_read_b128 v[44:47], v16 offset:96
    ds_read_b128 v[48:51], v17 offset:96
    s_waitcnt lgkmcnt(6)
    v_mfma_f32_32x32x16_bf16 v[64:79], v[24:27], v[20:23], 0
    ds_read_b128 v[20:23], v16 offset:128
    ds_read_b128 v[24:27], v17 offset:128
    s_waitcnt lgkmcnt(6)
    v_mfma_f32_32x32x16_bf16 v[64:79], v[32:35], v[28:31], v[64:79]
    ds_read_b128 v[28:31], v16 offset:160
    ds_read_b128 v[32:35], v17 offset:160
    s_waitcnt lgkmcnt(6)
    v_mfma_f32_32x32x16_bf16 v[64:79], v[40:43], v[36:39], v[64:79]
    ds_read_b128 v[36:39], v16 offset:192
    ds_read_b128 v[40:43], v17 offset:192
    s_waitcnt lgkmcnt(6)
    v_mfma_f32_32x32x16_bf16 v[64:79], v[48:51], v[44:47], v[64:79]
    ds_read_b128 v[44:47], v16 offset:224
    ds_read_b128 v[48:51], v17 offset:224
    s_waitcnt lgkmcnt(6)
    v_mfma_f32_32x32x16_bf16 v[64:79], v[24:27], v[20:23], v[64:79]
    ds_read_b128 v[20:23], v16 offset:256
    ds_read_b128 v[24:27], v17 offset:256
    s_waitcnt lgkmcnt(6)
    v_mfma_f32_32x32x16_bf16 v[64:79], v[32:35], v[28:31], v[64:79]
    ds_read_b128 v[28:31], v16 offset:288
    ds_read_b128 v[32:35], v17 offset:288
    s_waitcnt lgkmcnt(6)
    v_mfma_f32_32x32x16_bf16 v[64:79], v[40:43], v[36:39], v[64:79]
    ds_read_b128 v[36:39], v16 offset:320
    ds_read_b128 v[40:43], v17 offset:320
    s_waitcnt lgkmcnt(6)
    v_mfma_f32_32x32x16_bf16 v[64:79], v[48:51], v[44:47], v[64:79]
    ds_read_b128 v[44:47], v16 offset:352
    ds_read_b128 v[48:51], v17 offset:352
    s_waitcnt lgkmcnt(6)
    v_mfma_f32_32x32x16_bf16 v[64:79], v[24:27], v[20:23], v[64:79]
    ds_read_b128 v[20:23], v16 offset:384
    ds_read_b128 v[24:27], v17 offset:384
    s_waitcnt lgkmcnt(6)
    v_mfma_f32_32x32x16_bf16 v[64:79], v[32:35], v[28:31], v[64:79]
    ds_read_b128 v[28:31], v16 offset:416
    ds_read_b128 v[32:35], v17 offset:416
    s_waitcnt lgkmcnt(6)
    v_mfma_f32_32x32x16_bf16 v[64:79], v[40:43], v[36:39], v[64:79]
    ds_read_b128 v[36:39], v16 offset:448
    ds_read_b128 v[40:43], v17 offset:448
    s_waitcnt lgkmcnt(6)
    v_mfma_f32_32x32x16_bf16 v[64:79], v[48:51], v[44:47], v[64:79]
    ds_read_b128 v[44:47], v16 offset:480
    ds_read_b128 v[48:51], v17 offset:480
    s_waitcnt lgkmcnt(6)
    v_mfma_f32_32x32x16_bf16 v[64:79], v[24:27], v[20:23], v[64:79]
    s_waitcnt lgkmcnt(4)
    v_mfma_f32_32x32x16_bf16 v[64:79], v[32:35], v[28:31], v[64:79]
    s_waitcnt lgkmcnt(2)
    v_mfma_f32_32x32x16_bf16 v[64:79], v[40:43], v[36:39], v[64:79]
    s_waitcnt lgkmcnt(0)
    v_mfma_f32_32x32x16_bf16 v[64:79], v[48:51], v[44:47], v[64:79]
    s_mul_i32 s36, s30, 4352
    s_add_u32 s36, s36, 143360
    v_lshlrev_b32 v7, 6, v5
    v_lshl_add_u32 v7, v6, 3, v7
    v_add_u32 v7, s36, v7
    v_add_u32 v7, 64, v7
    s_mov_b32 s40, 0xff
    s_cmp_eq_u32 s39, 1
    s_cselect_b32 s40, 0xff00, s40
    s_cmp_eq_u32 s39, 2
    s_cselect_b32 s40, 0xffff0000, s40
    s_cmp_eq_u32 s39, 3
    s_cselect_b32 s40, -1, s40
    s_cselect_b32 s42, 2048, 0
    s_mov_b32 s41, s40
    v_add_u32 v7, s42, v7
    v_mov_b32 v20, 0
    v_lshlrev_b32 v21, 2, v2
    v_add_u32 v21, s36, v21
    s_nop 5
    v_cvt_pk_bf16_f32 v64, v64, v65
    v_cvt_pk_bf16_f32 v65, v66, v67
    v_cvt_pk_bf16_f32 v66, v68, v69
    v_cvt_pk_bf16_f32 v67, v70, v71
    v_cvt_pk_bf16_f32 v68, v72, v73
    v_cvt_pk_bf16_f32 v69, v74, v75
    v_cvt_pk_bf16_f32 v70, v76, v77
    v_cvt_pk_bf16_f32 v71, v78, v79
    s_mov_b64 exec, s[40:41]
    ds_write_b64 v7, v[64:65] offset:0
    ds_write_b64 v7, v[66:67] offset:16
    ds_write_b64 v7, v[68:69] offset:32
    ds_write_b64 v7, v[70:71] offset:48
    s_cmp_lg_u32 s39, 0
    s_cbranch_scc1 KG_NP
    s_mov_b64 exec, 0xffff
    ds_write_b32 v21, v20
    s_mov_b32 s40, -1
    s_mov_b32 s41, 0xffff
    s_mov_b64 exec, s[40:41]
    ds_write_b32 v21, v20 offset:4160
KG_NP:
    s_mov_b64 exec, -1
    s_waitcnt lgkmcnt(0)
    v_mov_b32 v18, 161800
    v_mov_b32 v19, 1
    s_mov_b64 exec, 1
    ds_add_u32 v18, v19
    s_mov_b64 exec, -1
    v_mov_b32 v18, 161800
    s_mov_b32 s42, 0x400000
LW_S2:
    ds_read_b32 v19, v18
    s_sub_u32 s42, s42, 1
    s_waitcnt lgkmcnt(0)
    v_readfirstlane_b32 s41, v19
    s_cmp_eq_u32 s42, 0
    s_cbranch_scc1 LWD_S2
    s_cmp_ge_u32 s41, 8
    s_cbranch_scc1 LWD_S2
    s_sleep 1
    s_branch LW_S2
LWD_S2:
    s_lshl_b32 s37, s39, 6
    v_add_u32 v5, s37, v2
    v_lshlrev_b32 v6, 4, v5
    v_add_u32 v7, s36, v6
    s_mul_i32 s38, s32, 8448
    s_add_u32 s38, s38, 10485760
    s_add_u32 s18, s62, s38
    s_addc_u32 s19, s63, 0
    v_add_u32 v8, 0x1000, v6
    v_add_u32 v30, 4224, v6
    v_add_u32 v42, 8320, v6
    ds_read_b128 v[20:23], v7
    ds_read_b32 v24, v7 offset:16
    ds_read_b128 v[32:35], v7 offset:4096
    ds_read_b32 v36, v7 offset:4112
    s_waitcnt lgkmcnt(0)
    v_alignbit_b32 v26, v21, v20, 16
    v_alignbit_b32 v27, v22, v21, 16
    v_alignbit_b32 v28, v23, v22, 16
    v_alignbit_b32 v29, v24, v23, 16
    global_store_dwordx4 v6, v[20:23], s[18:19]
    global_store_dwordx4 v30, v[26:29], s[18:19]
    v_cmp_gt_u32 vcc, 8, v5
    s_and_saveexec_b64 s[40:41], vcc
    s_cbranch_execz KG_RB_SKIP
    v_alignbit_b32 v38, v33, v32, 16
    v_alignbit_b32 v39, v34, v33, 16
    v_alignbit_b32 v40, v35, v34, 16
    v_alignbit_b32 v41, v36, v35, 16
    global_store_dwordx4 v8, v[32:35], s[18:19]
    global_store_dwordx4 v42, v[38:41], s[18:19]
KG_RB_SKIP:
    s_mov_b64 exec, -1
    v_mov_b32 v6, 161820
    ds_read_b32 v7, v6
    s_waitcnt lgkmcnt(0)
    v_readfirstlane_b32 s60, v7
    s_nop 3
    s_lshl_b32 s27, s25, 2
    s_and_b32 s28, s26, 3
    s_add_u32 s27, s27, s28
    s_lshr_b32 s28, s26, 2
    s_and_b32 s29, s24, 3
    s_lshr_b32 s30, s24, 2
    v_lshlrev_b32 v3, 4, v2
    s_mov_b32 s12, s62
    s_and_b32 s13, s63, 0xffff
    s_mov_b32 s14, 8388608
    s_mov_b32 s15, 0x20000
    s_lshl_b32 s34, s30, 16
    v_add_u32 v145, s34, v3
    v_and_b32 v4, 15, v2
    v_lshrrev_b32 v5, 5, v2
    v_lshlrev_b32 v4, 4, v4
    v_lshl_add_u32 v4, v5, 8, v4
    v_add_u32 v146, s34, v4
    v_mov_b32 v144, 0xdddd
    v_and_b32 v4, 31, v2
    v_cmp_eq_u32 vcc, 16, v4
    v_cmp_eq_u32 s[44:45], 20, v4
    s_nop 1
    s_or_b64 vcc, vcc, s[44:45]
    v_mov_b32 v5, 0x3f803f80
    v_mov_b32 v6, 0
    s_nop 1
    v_cndmask_b32 v6, v6, v5, vcc
    v_mov_b32 v128, v6
    v_mov_b32 v129, v6
    v_mov_b32 v130, v6
    v_mov_b32 v131, v6
    v_mov_b32 v132, v6
    v_mov_b32 v133, v6
    v_mov_b32 v134, v6
    v_mov_b32 v135, v6
    v_mov_b32 v136, v6
    v_mov_b32 v137, v6
    v_mov_b32 v138, v6
    v_mov_b32 v139, v6
    v_mov_b32 v140, v6
    v_mov_b32 v141, v6
    v_mov_b32 v142, v6
    v_mov_b32 v143, v6
    s_mov_b32 s46, 0xffff
    s_mov_b32 s47, 0xffff
    v_mov_b32 v80, 0
    v_mov_b32 v81, 0
    v_mov_b32 v82, 0
    v_mov_b32 v83, 0
    v_mov_b32 v84, 0
    v_mov_b32 v85, 0
    v_mov_b32 v86, 0
    v_mov_b32 v87, 0
    v_mov_b32 v88, 0
    v_mov_b32 v89, 0
    v_mov_b32 v90, 0
    v_mov_b32 v91, 0
    v_mov_b32 v92, 0
    v_mov_b32 v93, 0
    v_mov_b32 v94, 0
    v_mov_b32 v95, 0
    v_mov_b32 v96, 0
    v_mov_b32 v97, 0
    v_mov_b32 v98, 0
    v_mov_b32 v99, 0
    v_mov_b32 v100, 0
    v_mov_b32 v101, 0
    v_mov_b32 v102, 0
    v_mov_b32 v103, 0
    v_mov_b32 v104, 0
    v_mov_b32 v105, 0
    v_mov_b32 v106, 0
    v_mov_b32 v107, 0
    v_mov_b32 v108, 0
    v_mov_b32 v109, 0
    v_mov_b32 v110, 0
    v_mov_b32 v111, 0
    s_lshl_b32 s35, s29, 11
    s_add_u32 s35, s35, 152064
    v_add_u32 v4, s35, v3
    s_waitcnt vmcnt(0)
    s_barrier
    ds_read_b128 v[112:115], v4
    ds_read_b128 v[116:119], v4 offset:1024
    ds_read_b128 v[120:123], v145 offset:0
    ds_read_b128 v[124:127], v145 offset:1024
    s_mov_b64 exec, s[46:47]
    ds_read_b128 v[128:131], v146 offset:32768
    ds_read_b128 v[132:135], v146 offset:33280
    s_mov_b64 exec, -1
    s_lshl_b32 s57, s24, 2
    s_add_u32 s57, s57, 161856
    v_mov_b32 v150, s57
    s_xor_b32 s57, s57, 16
    v_mov_b32 v151, s57
    s_setprio 1
    s_waitcnt lgkmcnt(0)
    v_mov_b32 v154, 161824
    v_mov_b32 v155, 1
    s_mov_b64 exec, 1
    ds_add_u32 v154, v155
    s_mov_b64 exec, -1
    v_mfma_f32_32x32x16_bf16 v[16:31], v[120:123], v[112:115], 0
    v_mfma_f32_32x32x16_bf16 v[32:47], v[120:123], v[116:119], 0
    s_nop 9
.p2align 6
    s_waitcnt lgkmcnt(0)
    v_mfma_f32_32x32x16_bf16 v[48:63], v[124:127], v[112:115], 0
    v_exp_f32 v16, v16
    v_exp_f32 v17, v17
    v_exp_f32 v18, v18
    v_exp_f32 v19, v19
    ds_read_b128 v[120:123], v145 offset:2048
    s_mov_b64 exec, s[46:47]
    ds_read_b128 v[136:139], v146 offset:33792
    ds_read_b128 v[140:143], v146 offset:34304
    s_mov_b64 exec, -1
    v_exp_f32 v20, v20
    v_exp_f32 v21, v21
    v_exp_f32 v22, v22
    v_exp_f32 v23, v23
    v_exp_f32 v24, v24
    v_mfma_f32_32x32x16_bf16 v[64:79], v[124:127], v[116:119], 0
    v_exp_f32 v25, v25
    v_exp_f32 v26, v26
    v_exp_f32 v27, v27
    v_exp_f32 v28, v28
    v_exp_f32 v29, v29
    v_smfmac_f32_32x32x32_bf16 v[80:95], v[128:131], v[16:23], v144
    v_exp_f32 v30, v30
    v_exp_f32 v31, v31
    v_exp_f32 v32, v32
    v_exp_f32 v33, v33
    v_exp_f32 v34, v34
    v_smfmac_f32_32x32x32_bf16 v[80:95], v[132:135], v[24:31], v144
    v_exp_f32 v35, v35
    v_exp_f32 v36, v36
    v_exp_f32 v37, v37
    v_exp_f32 v38, v38
    v_exp_f32 v39, v39
    v_exp_f32 v40, v40
    v_exp_f32 v41, v41
    v_smfmac_f32_32x32x32_bf16 v[96:111], v[128:131], v[32:39], v144
    v_exp_f32 v42, v42
    v_exp_f32 v43, v43
    v_exp_f32 v44, v44
    v_exp_f32 v45, v45
    v_exp_f32 v46, v46
    v_exp_f32 v47, v47
    v_mov_b32 v152, 161828
    s_mov_b32 s58, 0x400000
LW_C0B:
    ds_read_b32 v153, v152
    s_sub_u32 s58, s58, 1
    s_waitcnt lgkmcnt(0)
    v_readfirstlane_b32 s57, v153
    s_cmp_eq_u32 s58, 0
    s_cbranch_scc1 LWD_C0B
    s_cmp_ge_u32 s57, 4
    s_cbranch_scc1 LWD_C0B
    s_sleep 1
    s_branch LW_C0B
LWD_C0B:
    s_waitcnt lgkmcnt(0)
    v_mfma_f32_32x32x16_bf16 v[16:31], v[120:123], v[112:115], 0
    v_exp_f32 v48, v48
    v_exp_f32 v49, v49
    v_exp_f32 v50, v50
    v_exp_f32 v51, v51
    v_smfmac_f32_32x32x32_bf16 v[96:111], v[132:135], v[40:47], v144
    ds_read_b128 v[124:127], v145 offset:3072
    s_mov_b64 exec, s[46:47]
    ds_read_b128 v[128:131], v146 offset:34816
    ds_read_b128 v[132:135], v146 offset:35328
    s_mov_b64 exec, -1
    v_exp_f32 v52, v52
    v_exp_f32 v53, v53
    v_exp_f32 v54, v54
    v_exp_f32 v55, v55
    v_exp_f32 v56, v56
    v_mfma_f32_32x32x16_bf16 v[32:47], v[120:123], v[116:119], 0
    v_exp_f32 v57, v57
    v_exp_f32 v58, v58
    v_exp_f32 v59, v59
    v_exp_f32 v60, v60
    v_exp_f32 v61, v61
    v_smfmac_f32_32x32x32_bf16 v[80:95], v[136:139], v[48:55], v144
    v_exp_f32 v62, v62
    v_exp_f32 v63, v63
    v_exp_f32 v64, v64
    v_exp_f32 v65, v65
    v_exp_f32 v66, v66
    v_smfmac_f32_32x32x32_bf16 v[80:95], v[140:143], v[56:63], v144
    v_exp_f32 v67, v67
    v_exp_f32 v68, v68
    v_exp_f32 v69, v69
    v_exp_f32 v70, v70
    v_exp_f32 v71, v71
    v_exp_f32 v72, v72
    v_exp_f32 v73, v73
    v_smfmac_f32_32x32x32_bf16 v[96:111], v[136:139], v[64:71], v144
    v_exp_f32 v74, v74
    v_exp_f32 v75, v75
    v_exp_f32 v76, v76
    v_exp_f32 v77, v77
    v_exp_f32 v78, v78
    v_exp_f32 v79, v79
    s_waitcnt lgkmcnt(0)
    v_mfma_f32_32x32x16_bf16 v[48:63], v[124:127], v[112:115], 0
    v_exp_f32 v16, v16
    v_exp_f32 v17, v17
    v_exp_f32 v18, v18
    v_exp_f32 v19, v19
    v_smfmac_f32_32x32x32_bf16 v[96:111], v[140:143], v[72:79], v144
    ds_read_b128 v[120:123], v145 offset:4096
    s_mov_b64 exec, s[46:47]
    ds_read_b128 v[136:139], v146 offset:35840
    ds_read_b128 v[140:143], v146 offset:36352
    s_mov_b64 exec, -1
    v_exp_f32 v20, v20
    v_exp_f32 v21, v21
    v_exp_f32 v22, v22
    v_exp_f32 v23, v23
    v_exp_f32 v24, v24
    v_mfma_f32_32x32x16_bf16 v[64:79], v[124:127], v[116:119], 0
    v_exp_f32 v25, v25
    v_exp_f32 v26, v26
    v_exp_f32 v27, v27
    v_exp_f32 v28, v28
    v_exp_f32 v29, v29
    v_smfmac_f32_32x32x32_bf16 v[80:95], v[128:131], v[16:23], v144
    v_exp_f32 v30, v30
    v_exp_f32 v31, v31
    v_exp_f32 v32, v32
    v_exp_f32 v33, v33
    v_exp_f32 v34, v34
    v_smfmac_f32_32x32x32_bf16 v[80:95], v[132:135], v[24:31], v144
    v_exp_f32 v35, v35
    v_exp_f32 v36, v36
    v_exp_f32 v37, v37
    v_exp_f32 v38, v38
    v_exp_f32 v39, v39
    v_exp_f32 v40, v40
    v_exp_f32 v41, v41
    v_smfmac_f32_32x32x32_bf16 v[96:111], v[128:131], v[32:39], v144
    v_exp_f32 v42, v42
    v_exp_f32 v43, v43
    v_exp_f32 v44, v44
    v_exp_f32 v45, v45
    v_exp_f32 v46, v46
    v_exp_f32 v47, v47
    s_waitcnt lgkmcnt(0)
    v_mfma_f32_32x32x16_bf16 v[16:31], v[120:123], v[112:115], 0
    v_mov_b32 v148, 4
    ds_write_b32 v150, v148
    ds_read_b32 v149, v151
    v_exp_f32 v48, v48
    v_exp_f32 v49, v49
    v_exp_f32 v50, v50
    v_exp_f32 v51, v51
    v_smfmac_f32_32x32x32_bf16 v[96:111], v[132:135], v[40:47], v144
    ds_read_b128 v[124:127], v145 offset:5120
    s_mov_b64 exec, s[46:47]
    ds_read_b128 v[128:131], v146 offset:36864
    ds_read_b128 v[132:135], v146 offset:37376
    s_mov_b64 exec, -1
    v_exp_f32 v52, v52
    v_exp_f32 v53, v53
    v_exp_f32 v54, v54
    v_exp_f32 v55, v55
    v_exp_f32 v56, v56
    v_mfma_f32_32x32x16_bf16 v[32:47], v[120:123], v[116:119], 0
    v_exp_f32 v57, v57
    v_exp_f32 v58, v58
    v_exp_f32 v59, v59
    v_exp_f32 v60, v60
    v_exp_f32 v61, v61
    v_smfmac_f32_32x32x32_bf16 v[80:95], v[136:139], v[48:55], v144
    v_exp_f32 v62, v62
    v_exp_f32 v63, v63
    v_exp_f32 v64, v64
    v_exp_f32 v65, v65
    v_exp_f32 v66, v66
    v_smfmac_f32_32x32x32_bf16 v[80:95], v[140:143], v[56:63], v144
    v_exp_f32 v67, v67
    v_exp_f32 v68, v68
    v_exp_f32 v69, v69
    v_exp_f32 v70, v70
    v_exp_f32 v71, v71
    v_exp_f32 v72, v72
    v_exp_f32 v73, v73
    v_smfmac_f32_32x32x32_bf16 v[96:111], v[136:139], v[64:71], v144
    v_exp_f32 v74, v74
    v_exp_f32 v75, v75
    v_exp_f32 v76, v76
    v_exp_f32 v77, v77
    v_exp_f32 v78, v78
    v_exp_f32 v79, v79
    v_mov_b32 v152, 161816
    ds_read_b32 v153, v152
    s_waitcnt lgkmcnt(0)
    v_readfirstlane_b32 s57, v149
    s_add_u32 s57, s57, s30
    s_cmp_gt_u32 s57, 4
    s_setprio 2
    s_cbranch_scc1 AT_PF4
    s_setprio 1
AT_PF4:
    v_mfma_f32_32x32x16_bf16 v[48:63], v[124:127], v[112:115], 0
    v_exp_f32 v16, v16
    v_exp_f32 v17, v17
    v_exp_f32 v18, v18
    v_exp_f32 v19, v19
    v_smfmac_f32_32x32x32_bf16 v[96:111], v[140:143], v[72:79], v144
    ds_read_b128 v[120:123], v145 offset:6144
    s_mov_b64 exec, s[46:47]
    ds_read_b128 v[136:139], v146 offset:37888
    ds_read_b128 v[140:143], v146 offset:38400
    s_mov_b64 exec, -1
    v_exp_f32 v20, v20
    v_exp_f32 v21, v21
    v_exp_f32 v22, v22
    v_exp_f32 v23, v23
    v_exp_f32 v24, v24
    v_mfma_f32_32x32x16_bf16 v[64:79], v[124:127], v[116:119], 0
    v_exp_f32 v25, v25
    v_exp_f32 v26, v26
    v_exp_f32 v27, v27
    v_exp_f32 v28, v28
    v_exp_f32 v29, v29
    v_smfmac_f32_32x32x32_bf16 v[80:95], v[128:131], v[16:23], v144
    v_exp_f32 v30, v30
    v_exp_f32 v31, v31
    v_exp_f32 v32, v32
    v_exp_f32 v33, v33
    v_exp_f32 v34, v34
    v_smfmac_f32_32x32x32_bf16 v[80:95], v[132:135], v[24:31], v144
    v_exp_f32 v35, v35
    v_exp_f32 v36, v36
    v_exp_f32 v37, v37
    v_exp_f32 v38, v38
    v_exp_f32 v39, v39
    v_exp_f32 v40, v40
    v_exp_f32 v41, v41
    v_smfmac_f32_32x32x32_bf16 v[96:111], v[128:131], v[32:39], v144
    v_exp_f32 v42, v42
    v_exp_f32 v43, v43
    v_exp_f32 v44, v44
    v_exp_f32 v45, v45
    v_exp_f32 v46, v46
    v_exp_f32 v47, v47
    s_waitcnt lgkmcnt(0)
    v_readfirstlane_b32 s57, v153
    s_cmp_ge_u32 s57, 4
    s_cbranch_scc1 AT_RD
    v_mov_b32 v152, 161816
    s_mov_b32 s58, 0x400000
LW_RD:
    ds_read_b32 v153, v152
    s_sub_u32 s58, s58, 1
    s_waitcnt lgkmcnt(0)
    v_readfirstlane_b32 s57, v153
    s_cmp_eq_u32 s58, 0
    s_cbranch_scc1 LWD_RD
    s_cmp_ge_u32 s57, 4
    s_cbranch_scc1 LWD_RD
    s_sleep 1
    s_branch LW_RD
LWD_RD:
AT_RD:
    s_waitcnt lgkmcnt(0)
    v_mfma_f32_32x32x16_bf16 v[16:31], v[120:123], v[112:115], 0
    v_exp_f32 v48, v48
    v_exp_f32 v49, v49
    v_exp_f32 v50, v50
    v_exp_f32 v51, v51
    v_smfmac_f32_32x32x32_bf16 v[96:111], v[132:135], v[40:47], v144
    ds_read_b128 v[124:127], v145 offset:7168
    s_mov_b64 exec, s[46:47]
    ds_read_b128 v[128:131], v146 offset:38912
    ds_read_b128 v[132:135], v146 offset:39424
    s_mov_b64 exec, -1
    v_exp_f32 v52, v52
    v_exp_f32 v53, v53
    v_exp_f32 v54, v54
    v_exp_f32 v55, v55
    v_exp_f32 v56, v56
    v_mfma_f32_32x32x16_bf16 v[32:47], v[120:123], v[116:119], 0
    v_exp_f32 v57, v57
    v_exp_f32 v58, v58
    v_exp_f32 v59, v59
    v_exp_f32 v60, v60
    v_exp_f32 v61, v61
    v_smfmac_f32_32x32x32_bf16 v[80:95], v[136:139], v[48:55], v144
    v_exp_f32 v62, v62
    v_exp_f32 v63, v63
    v_exp_f32 v64, v64
    v_exp_f32 v65, v65
    v_exp_f32 v66, v66
    v_smfmac_f32_32x32x32_bf16 v[80:95], v[140:143], v[56:63], v144
    v_exp_f32 v67, v67
    v_exp_f32 v68, v68
    v_exp_f32 v69, v69
    v_exp_f32 v70, v70
    v_exp_f32 v71, v71
    v_exp_f32 v72, v72
    v_exp_f32 v73, v73
    v_smfmac_f32_32x32x32_bf16 v[96:111], v[136:139], v[64:71], v144
    v_exp_f32 v74, v74
    v_exp_f32 v75, v75
    v_exp_f32 v76, v76
    v_exp_f32 v77, v77
    v_exp_f32 v78, v78
    v_exp_f32 v79, v79
    s_waitcnt lgkmcnt(0)
    v_mfma_f32_32x32x16_bf16 v[48:63], v[124:127], v[112:115], 0
    v_exp_f32 v16, v16
    v_exp_f32 v17, v17
    v_exp_f32 v18, v18
    v_exp_f32 v19, v19
    v_smfmac_f32_32x32x32_bf16 v[96:111], v[140:143], v[72:79], v144
    ds_read_b128 v[120:123], v145 offset:8192
    s_mov_b64 exec, s[46:47]
    ds_read_b128 v[136:139], v146 offset:39936
    ds_read_b128 v[140:143], v146 offset:40448
    s_mov_b64 exec, -1
    v_exp_f32 v20, v20
    v_exp_f32 v21, v21
    v_exp_f32 v22, v22
    v_exp_f32 v23, v23
    v_exp_f32 v24, v24
    v_mfma_f32_32x32x16_bf16 v[64:79], v[124:127], v[116:119], 0
    v_exp_f32 v25, v25
    v_exp_f32 v26, v26
    v_exp_f32 v27, v27
    v_exp_f32 v28, v28
    v_exp_f32 v29, v29
    v_smfmac_f32_32x32x32_bf16 v[80:95], v[128:131], v[16:23], v144
    v_exp_f32 v30, v30
    v_exp_f32 v31, v31
    v_exp_f32 v32, v32
    v_exp_f32 v33, v33
    v_exp_f32 v34, v34
    v_smfmac_f32_32x32x32_bf16 v[80:95], v[132:135], v[24:31], v144
    v_exp_f32 v35, v35
    v_exp_f32 v36, v36
    v_exp_f32 v37, v37
    v_exp_f32 v38, v38
    v_exp_f32 v39, v39
    v_exp_f32 v40, v40
    v_exp_f32 v41, v41
    v_smfmac_f32_32x32x32_bf16 v[96:111], v[128:131], v[32:39], v144
    v_exp_f32 v42, v42
    v_exp_f32 v43, v43
    v_exp_f32 v44, v44
    v_exp_f32 v45, v45
    v_exp_f32 v46, v46
    v_exp_f32 v47, v47
    s_waitcnt lgkmcnt(0)
    v_mfma_f32_32x32x16_bf16 v[16:31], v[120:123], v[112:115], 0
    v_mov_b32 v148, 8
    ds_write_b32 v150, v148
    ds_read_b32 v149, v151
    v_exp_f32 v48, v48
    v_exp_f32 v49, v49
    v_exp_f32 v50, v50
    v_exp_f32 v51, v51
    v_smfmac_f32_32x32x32_bf16 v[96:111], v[132:135], v[40:47], v144
    ds_read_b128 v[124:127], v145 offset:9216
    s_mov_b64 exec, s[46:47]
    ds_read_b128 v[128:131], v146 offset:40960
    ds_read_b128 v[132:135], v146 offset:41472
    s_mov_b64 exec, -1
    v_exp_f32 v52, v52
    v_exp_f32 v53, v53
    v_exp_f32 v54, v54
    v_exp_f32 v55, v55
    v_exp_f32 v56, v56
    v_mfma_f32_32x32x16_bf16 v[32:47], v[120:123], v[116:119], 0
    v_exp_f32 v57, v57
    v_exp_f32 v58, v58
    v_exp_f32 v59, v59
    v_exp_f32 v60, v60
    v_exp_f32 v61, v61
    v_smfmac_f32_32x32x32_bf16 v[80:95], v[136:139], v[48:55], v144
    v_exp_f32 v62, v62
    v_exp_f32 v63, v63
    v_exp_f32 v64, v64
    v_exp_f32 v65, v65
    v_exp_f32 v66, v66
    v_smfmac_f32_32x32x32_bf16 v[80:95], v[140:143], v[56:63], v144
    v_exp_f32 v67, v67
    v_exp_f32 v68, v68
    v_exp_f32 v69, v69
    v_exp_f32 v70, v70
    v_exp_f32 v71, v71
    v_exp_f32 v72, v72
    v_exp_f32 v73, v73
    v_smfmac_f32_32x32x32_bf16 v[96:111], v[136:139], v[64:71], v144
    v_exp_f32 v74, v74
    v_exp_f32 v75, v75
    v_exp_f32 v76, v76
    v_exp_f32 v77, v77
    v_exp_f32 v78, v78
    v_exp_f32 v79, v79
    s_waitcnt lgkmcnt(0)
    v_readfirstlane_b32 s57, v149
    s_add_u32 s57, s57, s30
    s_cmp_gt_u32 s57, 8
    s_setprio 2
    s_cbranch_scc1 AT_PF8
    s_setprio 1
AT_PF8:
    v_mfma_f32_32x32x16_bf16 v[48:63], v[124:127], v[112:115], 0
    v_exp_f32 v16, v16
    v_exp_f32 v17, v17
    v_exp_f32 v18, v18
    v_exp_f32 v19, v19
    v_smfmac_f32_32x32x32_bf16 v[96:111], v[140:143], v[72:79], v144
    ds_read_b128 v[120:123], v145 offset:10240
    s_mov_b64 exec, s[46:47]
    ds_read_b128 v[136:139], v146 offset:41984
    ds_read_b128 v[140:143], v146 offset:42496
    s_mov_b64 exec, -1
    v_exp_f32 v20, v20
    v_exp_f32 v21, v21
    v_exp_f32 v22, v22
    v_exp_f32 v23, v23
    v_exp_f32 v24, v24
    v_mfma_f32_32x32x16_bf16 v[64:79], v[124:127], v[116:119], 0
    v_exp_f32 v25, v25
    v_exp_f32 v26, v26
    v_exp_f32 v27, v27
    v_exp_f32 v28, v28
    v_exp_f32 v29, v29
    v_smfmac_f32_32x32x32_bf16 v[80:95], v[128:131], v[16:23], v144
    v_exp_f32 v30, v30
    v_exp_f32 v31, v31
    v_exp_f32 v32, v32
    v_exp_f32 v33, v33
    v_exp_f32 v34, v34
    v_smfmac_f32_32x32x32_bf16 v[80:95], v[132:135], v[24:31], v144
    v_exp_f32 v35, v35
    v_exp_f32 v36, v36
    v_exp_f32 v37, v37
    v_exp_f32 v38, v38
    v_exp_f32 v39, v39
    v_exp_f32 v40, v40
    v_exp_f32 v41, v41
    v_smfmac_f32_32x32x32_bf16 v[96:111], v[128:131], v[32:39], v144
    v_exp_f32 v42, v42
    v_exp_f32 v43, v43
    v_exp_f32 v44, v44
    v_exp_f32 v45, v45
    v_exp_f32 v46, v46
    v_exp_f32 v47, v47
    s_waitcnt lgkmcnt(0)
    v_mfma_f32_32x32x16_bf16 v[16:31], v[120:123], v[112:115], 0
    v_exp_f32 v48, v48
    v_exp_f32 v49, v49
    v_exp_f32 v50, v50
    v_exp_f32 v51, v51
    v_smfmac_f32_32x32x32_bf16 v[96:111], v[132:135], v[40:47], v144
    ds_read_b128 v[124:127], v145 offset:11264
    s_mov_b64 exec, s[46:47]
    ds_read_b128 v[128:131], v146 offset:43008
    ds_read_b128 v[132:135], v146 offset:43520
    s_mov_b64 exec, -1
    v_exp_f32 v52, v52
    v_exp_f32 v53, v53
    v_exp_f32 v54, v54
    v_exp_f32 v55, v55
    v_exp_f32 v56, v56
    v_mfma_f32_32x32x16_bf16 v[32:47], v[120:123], v[116:119], 0
    v_exp_f32 v57, v57
    v_exp_f32 v58, v58
    v_exp_f32 v59, v59
    v_exp_f32 v60, v60
    v_exp_f32 v61, v61
    v_smfmac_f32_32x32x32_bf16 v[80:95], v[136:139], v[48:55], v144
    v_exp_f32 v62, v62
    v_exp_f32 v63, v63
    v_exp_f32 v64, v64
    v_exp_f32 v65, v65
    v_exp_f32 v66, v66
    v_smfmac_f32_32x32x32_bf16 v[80:95], v[140:143], v[56:63], v144
    v_exp_f32 v67, v67
    v_exp_f32 v68, v68
    v_exp_f32 v69, v69
    v_exp_f32 v70, v70
    v_exp_f32 v71, v71
    v_exp_f32 v72, v72
    v_exp_f32 v73, v73
    v_smfmac_f32_32x32x32_bf16 v[96:111], v[136:139], v[64:71], v144
    v_exp_f32 v74, v74
    v_exp_f32 v75, v75
    v_exp_f32 v76, v76
    v_exp_f32 v77, v77
    v_exp_f32 v78, v78
    v_exp_f32 v79, v79
    s_waitcnt lgkmcnt(0)
    v_mfma_f32_32x32x16_bf16 v[48:63], v[124:127], v[112:115], 0
    v_exp_f32 v16, v16
    v_exp_f32 v17, v17
    v_exp_f32 v18, v18
    v_exp_f32 v19, v19
    v_smfmac_f32_32x32x32_bf16 v[96:111], v[140:143], v[72:79], v144
    ds_read_b128 v[120:123], v145 offset:12288
    s_mov_b64 exec, s[46:47]
    ds_read_b128 v[136:139], v146 offset:44032
    ds_read_b128 v[140:143], v146 offset:44544
    s_mov_b64 exec, -1
    v_exp_f32 v20, v20
    v_exp_f32 v21, v21
    v_exp_f32 v22, v22
    v_exp_f32 v23, v23
    v_exp_f32 v24, v24
    v_mfma_f32_32x32x16_bf16 v[64:79], v[124:127], v[116:119], 0
    v_exp_f32 v25, v25
    v_exp_f32 v26, v26
    v_exp_f32 v27, v27
    v_exp_f32 v28, v28
    v_exp_f32 v29, v29
    v_smfmac_f32_32x32x32_bf16 v[80:95], v[128:131], v[16:23], v144
    v_exp_f32 v30, v30
    v_exp_f32 v31, v31
    v_exp_f32 v32, v32
    v_exp_f32 v33, v33
    v_exp_f32 v34, v34
    v_smfmac_f32_32x32x32_bf16 v[80:95], v[132:135], v[24:31], v144
    v_exp_f32 v35, v35
    v_exp_f32 v36, v36
    v_exp_f32 v37, v37
    v_exp_f32 v38, v38
    v_exp_f32 v39, v39
    v_exp_f32 v40, v40
    v_exp_f32 v41, v41
    v_smfmac_f32_32x32x32_bf16 v[96:111], v[128:131], v[32:39], v144
    v_exp_f32 v42, v42
    v_exp_f32 v43, v43
    v_exp_f32 v44, v44
    v_exp_f32 v45, v45
    v_exp_f32 v46, v46
    v_exp_f32 v47, v47
    s_waitcnt lgkmcnt(0)
    v_mfma_f32_32x32x16_bf16 v[16:31], v[120:123], v[112:115], 0
    v_mov_b32 v148, 12
    ds_write_b32 v150, v148
    ds_read_b32 v149, v151
    v_exp_f32 v48, v48
    v_exp_f32 v49, v49
    v_exp_f32 v50, v50
    v_exp_f32 v51, v51
    v_smfmac_f32_32x32x32_bf16 v[96:111], v[132:135], v[40:47], v144
    ds_read_b128 v[124:127], v145 offset:13312
    s_mov_b64 exec, s[46:47]
    ds_read_b128 v[128:131], v146 offset:45056
    ds_read_b128 v[132:135], v146 offset:45568
    s_mov_b64 exec, -1
    v_exp_f32 v52, v52
    v_exp_f32 v53, v53
    v_exp_f32 v54, v54
    v_exp_f32 v55, v55
    v_exp_f32 v56, v56
    v_mfma_f32_32x32x16_bf16 v[32:47], v[120:123], v[116:119], 0
    v_exp_f32 v57, v57
    v_exp_f32 v58, v58
    v_exp_f32 v59, v59
    v_exp_f32 v60, v60
    v_exp_f32 v61, v61
    v_smfmac_f32_32x32x32_bf16 v[80:95], v[136:139], v[48:55], v144
    v_exp_f32 v62, v62
    v_exp_f32 v63, v63
    v_exp_f32 v64, v64
    v_exp_f32 v65, v65
    v_exp_f32 v66, v66
    v_smfmac_f32_32x32x32_bf16 v[80:95], v[140:143], v[56:63], v144
    v_exp_f32 v67, v67
    v_exp_f32 v68, v68
    v_exp_f32 v69, v69
    v_exp_f32 v70, v70
    v_exp_f32 v71, v71
    v_exp_f32 v72, v72
    v_exp_f32 v73, v73
    v_smfmac_f32_32x32x32_bf16 v[96:111], v[136:139], v[64:71], v144
    v_exp_f32 v74, v74
    v_exp_f32 v75, v75
    v_exp_f32 v76, v76
    v_exp_f32 v77, v77
    v_exp_f32 v78, v78
    v_exp_f32 v79, v79
    s_waitcnt lgkmcnt(0)
    v_readfirstlane_b32 s57, v149
    s_add_u32 s57, s57, s30
    s_cmp_gt_u32 s57, 12
    s_setprio 2
    s_cbranch_scc1 AT_PF12
    s_setprio 1
AT_PF12:
    v_mfma_f32_32x32x16_bf16 v[48:63], v[124:127], v[112:115], 0
    v_exp_f32 v16, v16
    v_exp_f32 v17, v17
    v_exp_f32 v18, v18
    v_exp_f32 v19, v19
    v_smfmac_f32_32x32x32_bf16 v[96:111], v[140:143], v[72:79], v144
    ds_read_b128 v[120:123], v145 offset:14336
    s_mov_b64 exec, s[46:47]
    ds_read_b128 v[136:139], v146 offset:46080
    ds_read_b128 v[140:143], v146 offset:46592
    s_mov_b64 exec, -1
    v_exp_f32 v20, v20
    v_exp_f32 v21, v21
    v_exp_f32 v22, v22
    v_exp_f32 v23, v23
    v_exp_f32 v24, v24
    v_mfma_f32_32x32x16_bf16 v[64:79], v[124:127], v[116:119], 0
    v_exp_f32 v25, v25
    v_exp_f32 v26, v26
    v_exp_f32 v27, v27
    v_exp_f32 v28, v28
    v_exp_f32 v29, v29
    v_smfmac_f32_32x32x32_bf16 v[80:95], v[128:131], v[16:23], v144
    v_exp_f32 v30, v30
    v_exp_f32 v31, v31
    v_exp_f32 v32, v32
    v_exp_f32 v33, v33
    v_exp_f32 v34, v34
    v_smfmac_f32_32x32x32_bf16 v[80:95], v[132:135], v[24:31], v144
    v_exp_f32 v35, v35
    v_exp_f32 v36, v36
    v_exp_f32 v37, v37
    v_exp_f32 v38, v38
    v_exp_f32 v39, v39
    v_exp_f32 v40, v40
    v_exp_f32 v41, v41
    v_smfmac_f32_32x32x32_bf16 v[96:111], v[128:131], v[32:39], v144
    v_exp_f32 v42, v42
    v_exp_f32 v43, v43
    v_exp_f32 v44, v44
    v_exp_f32 v45, v45
    v_exp_f32 v46, v46
    v_exp_f32 v47, v47
    s_waitcnt lgkmcnt(0)
    v_mfma_f32_32x32x16_bf16 v[16:31], v[120:123], v[112:115], 0
    v_exp_f32 v48, v48
    v_exp_f32 v49, v49
    v_exp_f32 v50, v50
    v_exp_f32 v51, v51
    v_smfmac_f32_32x32x32_bf16 v[96:111], v[132:135], v[40:47], v144
    ds_read_b128 v[124:127], v145 offset:15360
    s_mov_b64 exec, s[46:47]
    ds_read_b128 v[128:131], v146 offset:47104
    ds_read_b128 v[132:135], v146 offset:47616
    s_mov_b64 exec, -1
    v_exp_f32 v52, v52
    v_exp_f32 v53, v53
    v_exp_f32 v54, v54
    v_exp_f32 v55, v55
    v_exp_f32 v56, v56
    v_mfma_f32_32x32x16_bf16 v[32:47], v[120:123], v[116:119], 0
    v_exp_f32 v57, v57
    v_exp_f32 v58, v58
    v_exp_f32 v59, v59
    v_exp_f32 v60, v60
    v_exp_f32 v61, v61
    v_smfmac_f32_32x32x32_bf16 v[80:95], v[136:139], v[48:55], v144
    v_exp_f32 v62, v62
    v_exp_f32 v63, v63
    v_exp_f32 v64, v64
    v_exp_f32 v65, v65
    v_exp_f32 v66, v66
    v_smfmac_f32_32x32x32_bf16 v[80:95], v[140:143], v[56:63], v144
    v_exp_f32 v67, v67
    v_exp_f32 v68, v68
    v_exp_f32 v69, v69
    v_exp_f32 v70, v70
    v_exp_f32 v71, v71
    v_exp_f32 v72, v72
    v_exp_f32 v73, v73
    v_smfmac_f32_32x32x32_bf16 v[96:111], v[136:139], v[64:71], v144
    v_exp_f32 v74, v74
    v_exp_f32 v75, v75
    v_exp_f32 v76, v76
    v_exp_f32 v77, v77
    v_exp_f32 v78, v78
    v_exp_f32 v79, v79
    s_waitcnt lgkmcnt(0)
    v_mfma_f32_32x32x16_bf16 v[48:63], v[124:127], v[112:115], 0
    v_exp_f32 v16, v16
    v_exp_f32 v17, v17
    v_exp_f32 v18, v18
    v_exp_f32 v19, v19
    v_smfmac_f32_32x32x32_bf16 v[96:111], v[140:143], v[72:79], v144
    ds_read_b128 v[120:123], v145 offset:16384
    s_mov_b64 exec, s[46:47]
    ds_read_b128 v[136:139], v146 offset:48128
    ds_read_b128 v[140:143], v146 offset:48640
    s_mov_b64 exec, -1
    v_exp_f32 v20, v20
    v_exp_f32 v21, v21
    v_exp_f32 v22, v22
    v_exp_f32 v23, v23
    v_exp_f32 v24, v24
    v_mfma_f32_32x32x16_bf16 v[64:79], v[124:127], v[116:119], 0
    v_exp_f32 v25, v25
    v_exp_f32 v26, v26
    v_exp_f32 v27, v27
    v_exp_f32 v28, v28
    v_exp_f32 v29, v29
    v_smfmac_f32_32x32x32_bf16 v[80:95], v[128:131], v[16:23], v144
    v_exp_f32 v30, v30
    v_exp_f32 v31, v31
    v_exp_f32 v32, v32
    v_exp_f32 v33, v33
    v_exp_f32 v34, v34
    v_smfmac_f32_32x32x32_bf16 v[80:95], v[132:135], v[24:31], v144
    v_exp_f32 v35, v35
    v_exp_f32 v36, v36
    v_exp_f32 v37, v37
    v_exp_f32 v38, v38
    v_exp_f32 v39, v39
    v_exp_f32 v40, v40
    v_exp_f32 v41, v41
    v_smfmac_f32_32x32x32_bf16 v[96:111], v[128:131], v[32:39], v144
    v_exp_f32 v42, v42
    v_exp_f32 v43, v43
    v_exp_f32 v44, v44
    v_exp_f32 v45, v45
    v_exp_f32 v46, v46
    v_exp_f32 v47, v47
    s_waitcnt lgkmcnt(0)
    v_mfma_f32_32x32x16_bf16 v[16:31], v[120:123], v[112:115], 0
    v_mov_b32 v148, 16
    ds_write_b32 v150, v148
    ds_read_b32 v149, v151
    v_exp_f32 v48, v48
    v_exp_f32 v49, v49
    v_exp_f32 v50, v50
    v_exp_f32 v51, v51
    v_smfmac_f32_32x32x32_bf16 v[96:111], v[132:135], v[40:47], v144
    ds_read_b128 v[124:127], v145 offset:17408
    s_mov_b64 exec, s[46:47]
    ds_read_b128 v[128:131], v146 offset:49152
    ds_read_b128 v[132:135], v146 offset:49664
    s_mov_b64 exec, -1
    v_exp_f32 v52, v52
    v_exp_f32 v53, v53
    v_exp_f32 v54, v54
    v_exp_f32 v55, v55
    v_exp_f32 v56, v56
    v_mfma_f32_32x32x16_bf16 v[32:47], v[120:123], v[116:119], 0
    v_exp_f32 v57, v57
    v_exp_f32 v58, v58
    v_exp_f32 v59, v59
    v_exp_f32 v60, v60
    v_exp_f32 v61, v61
    v_smfmac_f32_32x32x32_bf16 v[80:95], v[136:139], v[48:55], v144
    v_exp_f32 v62, v62
    v_exp_f32 v63, v63
    v_exp_f32 v64, v64
    v_exp_f32 v65, v65
    v_exp_f32 v66, v66
    v_smfmac_f32_32x32x32_bf16 v[80:95], v[140:143], v[56:63], v144
    v_exp_f32 v67, v67
    v_exp_f32 v68, v68
    v_exp_f32 v69, v69
    v_exp_f32 v70, v70
    v_exp_f32 v71, v71
    v_exp_f32 v72, v72
    v_exp_f32 v73, v73
    v_smfmac_f32_32x32x32_bf16 v[96:111], v[136:139], v[64:71], v144
    v_exp_f32 v74, v74
    v_exp_f32 v75, v75
    v_exp_f32 v76, v76
    v_exp_f32 v77, v77
    v_exp_f32 v78, v78
    v_exp_f32 v79, v79
    s_waitcnt lgkmcnt(0)
    v_readfirstlane_b32 s57, v149
    s_add_u32 s57, s57, s30
    s_cmp_gt_u32 s57, 16
    s_setprio 2
    s_cbranch_scc1 AT_PF16
    s_setprio 1
AT_PF16:
    v_mfma_f32_32x32x16_bf16 v[48:63], v[124:127], v[112:115], 0
    v_exp_f32 v16, v16
    v_exp_f32 v17, v17
    v_exp_f32 v18, v18
    v_exp_f32 v19, v19
    v_smfmac_f32_32x32x32_bf16 v[96:111], v[140:143], v[72:79], v144
    ds_read_b128 v[120:123], v145 offset:18432
    s_mov_b64 exec, s[46:47]
    ds_read_b128 v[136:139], v146 offset:50176
    ds_read_b128 v[140:143], v146 offset:50688
    s_mov_b64 exec, -1
    v_exp_f32 v20, v20
    v_exp_f32 v21, v21
    v_exp_f32 v22, v22
    v_exp_f32 v23, v23
    v_exp_f32 v24, v24
    v_mfma_f32_32x32x16_bf16 v[64:79], v[124:127], v[116:119], 0
    v_exp_f32 v25, v25
    v_exp_f32 v26, v26
    v_exp_f32 v27, v27
    v_exp_f32 v28, v28
    v_exp_f32 v29, v29
    v_smfmac_f32_32x32x32_bf16 v[80:95], v[128:131], v[16:23], v144
    v_exp_f32 v30, v30
    v_exp_f32 v31, v31
    v_exp_f32 v32, v32
    v_exp_f32 v33, v33
    v_exp_f32 v34, v34
    v_smfmac_f32_32x32x32_bf16 v[80:95], v[132:135], v[24:31], v144
    v_exp_f32 v35, v35
    v_exp_f32 v36, v36
    v_exp_f32 v37, v37
    v_exp_f32 v38, v38
    v_exp_f32 v39, v39
    v_exp_f32 v40, v40
    v_exp_f32 v41, v41
    v_smfmac_f32_32x32x32_bf16 v[96:111], v[128:131], v[32:39], v144
    v_exp_f32 v42, v42
    v_exp_f32 v43, v43
    v_exp_f32 v44, v44
    v_exp_f32 v45, v45
    v_exp_f32 v46, v46
    v_exp_f32 v47, v47
    s_waitcnt lgkmcnt(0)
    v_mfma_f32_32x32x16_bf16 v[16:31], v[120:123], v[112:115], 0
    v_exp_f32 v48, v48
    v_exp_f32 v49, v49
    v_exp_f32 v50, v50
    v_exp_f32 v51, v51
    v_smfmac_f32_32x32x32_bf16 v[96:111], v[132:135], v[40:47], v144
    ds_read_b128 v[124:127], v145 offset:19456
    s_mov_b64 exec, s[46:47]
    ds_read_b128 v[128:131], v146 offset:51200
    ds_read_b128 v[132:135], v146 offset:51712
    s_mov_b64 exec, -1
    v_exp_f32 v52, v52
    v_exp_f32 v53, v53
    v_exp_f32 v54, v54
    v_exp_f32 v55, v55
    v_exp_f32 v56, v56
    v_mfma_f32_32x32x16_bf16 v[32:47], v[120:123], v[116:119], 0
    v_exp_f32 v57, v57
    v_exp_f32 v58, v58
    v_exp_f32 v59, v59
    v_exp_f32 v60, v60
    v_exp_f32 v61, v61
    v_smfmac_f32_32x32x32_bf16 v[80:95], v[136:139], v[48:55], v144
    v_exp_f32 v62, v62
    v_exp_f32 v63, v63
    v_exp_f32 v64, v64
    v_exp_f32 v65, v65
    v_exp_f32 v66, v66
    v_smfmac_f32_32x32x32_bf16 v[80:95], v[140:143], v[56:63], v144
    v_exp_f32 v67, v67
    v_exp_f32 v68, v68
    v_exp_f32 v69, v69
    v_exp_f32 v70, v70
    v_exp_f32 v71, v71
    v_exp_f32 v72, v72
    v_exp_f32 v73, v73
    v_smfmac_f32_32x32x32_bf16 v[96:111], v[136:139], v[64:71], v144
    v_exp_f32 v74, v74
    v_exp_f32 v75, v75
    v_exp_f32 v76, v76
    v_exp_f32 v77, v77
    v_exp_f32 v78, v78
    v_exp_f32 v79, v79
    s_waitcnt lgkmcnt(0)
    v_mfma_f32_32x32x16_bf16 v[48:63], v[124:127], v[112:115], 0
    v_exp_f32 v16, v16
    v_exp_f32 v17, v17
    v_exp_f32 v18, v18
    v_exp_f32 v19, v19
    v_smfmac_f32_32x32x32_bf16 v[96:111], v[140:143], v[72:79], v144
    ds_read_b128 v[120:123], v145 offset:20480
    s_mov_b64 exec, s[46:47]
    ds_read_b128 v[136:139], v146 offset:52224
    ds_read_b128 v[140:143], v146 offset:52736
    s_mov_b64 exec, -1
    v_exp_f32 v20, v20
    v_exp_f32 v21, v21
    v_exp_f32 v22, v22
    v_exp_f32 v23, v23
    v_exp_f32 v24, v24
    v_mfma_f32_32x32x16_bf16 v[64:79], v[124:127], v[116:119], 0
    v_exp_f32 v25, v25
    v_exp_f32 v26, v26
    v_exp_f32 v27, v27
    v_exp_f32 v28, v28
    v_exp_f32 v29, v29
    v_smfmac_f32_32x32x32_bf16 v[80:95], v[128:131], v[16:23], v144
    v_exp_f32 v30, v30
    v_exp_f32 v31, v31
    v_exp_f32 v32, v32
    v_exp_f32 v33, v33
    v_exp_f32 v34, v34
    v_smfmac_f32_32x32x32_bf16 v[80:95], v[132:135], v[24:31], v144
    v_exp_f32 v35, v35
    v_exp_f32 v36, v36
    v_exp_f32 v37, v37
    v_exp_f32 v38, v38
    v_exp_f32 v39, v39
    v_exp_f32 v40, v40
    v_exp_f32 v41, v41
    v_smfmac_f32_32x32x32_bf16 v[96:111], v[128:131], v[32:39], v144
    v_exp_f32 v42, v42
    v_exp_f32 v43, v43
    v_exp_f32 v44, v44
    v_exp_f32 v45, v45
    v_exp_f32 v46, v46
    v_exp_f32 v47, v47
    s_waitcnt lgkmcnt(0)
    v_mfma_f32_32x32x16_bf16 v[16:31], v[120:123], v[112:115], 0
    v_mov_b32 v148, 20
    ds_write_b32 v150, v148
    ds_read_b32 v149, v151
    v_exp_f32 v48, v48
    v_exp_f32 v49, v49
    v_exp_f32 v50, v50
    v_exp_f32 v51, v51
    v_smfmac_f32_32x32x32_bf16 v[96:111], v[132:135], v[40:47], v144
    ds_read_b128 v[124:127], v145 offset:21504
    s_mov_b64 exec, s[46:47]
    ds_read_b128 v[128:131], v146 offset:53248
    ds_read_b128 v[132:135], v146 offset:53760
    s_mov_b64 exec, -1
    v_exp_f32 v52, v52
    v_exp_f32 v53, v53
    v_exp_f32 v54, v54
    v_exp_f32 v55, v55
    v_exp_f32 v56, v56
    v_mfma_f32_32x32x16_bf16 v[32:47], v[120:123], v[116:119], 0
    v_exp_f32 v57, v57
    v_exp_f32 v58, v58
    v_exp_f32 v59, v59
    v_exp_f32 v60, v60
    v_exp_f32 v61, v61
    v_smfmac_f32_32x32x32_bf16 v[80:95], v[136:139], v[48:55], v144
    v_exp_f32 v62, v62
    v_exp_f32 v63, v63
    v_exp_f32 v64, v64
    v_exp_f32 v65, v65
    v_exp_f32 v66, v66
    v_smfmac_f32_32x32x32_bf16 v[80:95], v[140:143], v[56:63], v144
    v_exp_f32 v67, v67
    v_exp_f32 v68, v68
    v_exp_f32 v69, v69
    v_exp_f32 v70, v70
    v_exp_f32 v71, v71
    v_exp_f32 v72, v72
    v_exp_f32 v73, v73
    v_smfmac_f32_32x32x32_bf16 v[96:111], v[136:139], v[64:71], v144
    v_exp_f32 v74, v74
    v_exp_f32 v75, v75
    v_exp_f32 v76, v76
    v_exp_f32 v77, v77
    v_exp_f32 v78, v78
    v_exp_f32 v79, v79
    s_waitcnt lgkmcnt(0)
    v_readfirstlane_b32 s57, v149
    s_add_u32 s57, s57, s30
    s_cmp_gt_u32 s57, 20
    s_setprio 2
    s_cbranch_scc1 AT_PF20
    s_setprio 1
AT_PF20:
    v_mfma_f32_32x32x16_bf16 v[48:63], v[124:127], v[112:115], 0
    v_exp_f32 v16, v16
    v_exp_f32 v17, v17
    v_exp_f32 v18, v18
    v_exp_f32 v19, v19
    v_smfmac_f32_32x32x32_bf16 v[96:111], v[140:143], v[72:79], v144
    ds_read_b128 v[120:123], v145 offset:22528
    s_mov_b64 exec, s[46:47]
    ds_read_b128 v[136:139], v146 offset:54272
    ds_read_b128 v[140:143], v146 offset:54784
    s_mov_b64 exec, -1
    v_exp_f32 v20, v20
    v_exp_f32 v21, v21
    v_exp_f32 v22, v22
    v_exp_f32 v23, v23
    v_exp_f32 v24, v24
    v_mfma_f32_32x32x16_bf16 v[64:79], v[124:127], v[116:119], 0
    v_exp_f32 v25, v25
    v_exp_f32 v26, v26
    v_exp_f32 v27, v27
    v_exp_f32 v28, v28
    v_exp_f32 v29, v29
    v_smfmac_f32_32x32x32_bf16 v[80:95], v[128:131], v[16:23], v144
    v_exp_f32 v30, v30
    v_exp_f32 v31, v31
    v_exp_f32 v32, v32
    v_exp_f32 v33, v33
    v_exp_f32 v34, v34
    v_smfmac_f32_32x32x32_bf16 v[80:95], v[132:135], v[24:31], v144
    v_exp_f32 v35, v35
    v_exp_f32 v36, v36
    v_exp_f32 v37, v37
    v_exp_f32 v38, v38
    v_exp_f32 v39, v39
    v_exp_f32 v40, v40
    v_exp_f32 v41, v41
    v_smfmac_f32_32x32x32_bf16 v[96:111], v[128:131], v[32:39], v144
    v_exp_f32 v42, v42
    v_exp_f32 v43, v43
    v_exp_f32 v44, v44
    v_exp_f32 v45, v45
    v_exp_f32 v46, v46
    v_exp_f32 v47, v47
    s_waitcnt lgkmcnt(0)
    v_mfma_f32_32x32x16_bf16 v[16:31], v[120:123], v[112:115], 0
    v_exp_f32 v48, v48
    v_exp_f32 v49, v49
    v_exp_f32 v50, v50
    v_exp_f32 v51, v51
    v_smfmac_f32_32x32x32_bf16 v[96:111], v[132:135], v[40:47], v144
    ds_read_b128 v[124:127], v145 offset:23552
    s_mov_b64 exec, s[46:47]
    ds_read_b128 v[128:131], v146 offset:55296
    ds_read_b128 v[132:135], v146 offset:55808
    s_mov_b64 exec, -1
    v_exp_f32 v52, v52
    v_exp_f32 v53, v53
    v_exp_f32 v54, v54
    v_exp_f32 v55, v55
    v_exp_f32 v56, v56
    v_mfma_f32_32x32x16_bf16 v[32:47], v[120:123], v[116:119], 0
    v_exp_f32 v57, v57
    v_exp_f32 v58, v58
    v_exp_f32 v59, v59
    v_exp_f32 v60, v60
    v_exp_f32 v61, v61
    v_smfmac_f32_32x32x32_bf16 v[80:95], v[136:139], v[48:55], v144
    v_exp_f32 v62, v62
    v_exp_f32 v63, v63
    v_exp_f32 v64, v64
    v_exp_f32 v65, v65
    v_exp_f32 v66, v66
    v_smfmac_f32_32x32x32_bf16 v[80:95], v[140:143], v[56:63], v144
    v_exp_f32 v67, v67
    v_exp_f32 v68, v68
    v_exp_f32 v69, v69
    v_exp_f32 v70, v70
    v_exp_f32 v71, v71
    v_exp_f32 v72, v72
    v_exp_f32 v73, v73
    v_smfmac_f32_32x32x32_bf16 v[96:111], v[136:139], v[64:71], v144
    v_exp_f32 v74, v74
    v_exp_f32 v75, v75
    v_exp_f32 v76, v76
    v_exp_f32 v77, v77
    v_exp_f32 v78, v78
    v_exp_f32 v79, v79
    s_waitcnt lgkmcnt(0)
    v_mfma_f32_32x32x16_bf16 v[48:63], v[124:127], v[112:115], 0
    v_exp_f32 v16, v16
    v_exp_f32 v17, v17
    v_exp_f32 v18, v18
    v_exp_f32 v19, v19
    v_smfmac_f32_32x32x32_bf16 v[96:111], v[140:143], v[72:79], v144
    ds_read_b128 v[120:123], v145 offset:24576
    s_mov_b64 exec, s[46:47]
    ds_read_b128 v[136:139], v146 offset:56320
    ds_read_b128 v[140:143], v146 offset:56832
    s_mov_b64 exec, -1
    v_exp_f32 v20, v20
    v_exp_f32 v21, v21
    v_exp_f32 v22, v22
    v_exp_f32 v23, v23
    v_exp_f32 v24, v24
    v_mfma_f32_32x32x16_bf16 v[64:79], v[124:127], v[116:119], 0
    v_exp_f32 v25, v25
    v_exp_f32 v26, v26
    v_exp_f32 v27, v27
    v_exp_f32 v28, v28
    v_exp_f32 v29, v29
    v_smfmac_f32_32x32x32_bf16 v[80:95], v[128:131], v[16:23], v144
    v_exp_f32 v30, v30
    v_exp_f32 v31, v31
    v_exp_f32 v32, v32
    v_exp_f32 v33, v33
    v_exp_f32 v34, v34
    v_smfmac_f32_32x32x32_bf16 v[80:95], v[132:135], v[24:31], v144
    v_exp_f32 v35, v35
    v_exp_f32 v36, v36
    v_exp_f32 v37, v37
    v_exp_f32 v38, v38
    v_exp_f32 v39, v39
    v_exp_f32 v40, v40
    v_exp_f32 v41, v41
    v_smfmac_f32_32x32x32_bf16 v[96:111], v[128:131], v[32:39], v144
    v_exp_f32 v42, v42
    v_exp_f32 v43, v43
    v_exp_f32 v44, v44
    v_exp_f32 v45, v45
    v_exp_f32 v46, v46
    v_exp_f32 v47, v47
    s_waitcnt lgkmcnt(0)
    v_mfma_f32_32x32x16_bf16 v[16:31], v[120:123], v[112:115], 0
    v_mov_b32 v148, 24
    ds_write_b32 v150, v148
    ds_read_b32 v149, v151
    v_exp_f32 v48, v48
    v_exp_f32 v49, v49
    v_exp_f32 v50, v50
    v_exp_f32 v51, v51
    v_smfmac_f32_32x32x32_bf16 v[96:111], v[132:135], v[40:47], v144
    ds_read_b128 v[124:127], v145 offset:25600
    s_mov_b64 exec, s[46:47]
    ds_read_b128 v[128:131], v146 offset:57344
    ds_read_b128 v[132:135], v146 offset:57856
    s_mov_b64 exec, -1
    v_exp_f32 v52, v52
    v_exp_f32 v53, v53
    v_exp_f32 v54, v54
    v_exp_f32 v55, v55
    v_exp_f32 v56, v56
    v_mfma_f32_32x32x16_bf16 v[32:47], v[120:123], v[116:119], 0
    v_exp_f32 v57, v57
    v_exp_f32 v58, v58
    v_exp_f32 v59, v59
    v_exp_f32 v60, v60
    v_exp_f32 v61, v61
    v_smfmac_f32_32x32x32_bf16 v[80:95], v[136:139], v[48:55], v144
    v_exp_f32 v62, v62
    v_exp_f32 v63, v63
    v_exp_f32 v64, v64
    v_exp_f32 v65, v65
    v_exp_f32 v66, v66
    v_smfmac_f32_32x32x32_bf16 v[80:95], v[140:143], v[56:63], v144
    v_exp_f32 v67, v67
    v_exp_f32 v68, v68
    v_exp_f32 v69, v69
    v_exp_f32 v70, v70
    v_exp_f32 v71, v71
    v_exp_f32 v72, v72
    v_exp_f32 v73, v73
    v_smfmac_f32_32x32x32_bf16 v[96:111], v[136:139], v[64:71], v144
    v_exp_f32 v74, v74
    v_exp_f32 v75, v75
    v_exp_f32 v76, v76
    v_exp_f32 v77, v77
    v_exp_f32 v78, v78
    v_exp_f32 v79, v79
    s_waitcnt lgkmcnt(0)
    v_readfirstlane_b32 s57, v149
    s_add_u32 s57, s57, s30
    s_cmp_gt_u32 s57, 24
    s_setprio 2
    s_cbranch_scc1 AT_PF24
    s_setprio 1
AT_PF24:
    v_mfma_f32_32x32x16_bf16 v[48:63], v[124:127], v[112:115], 0
    v_exp_f32 v16, v16
    v_exp_f32 v17, v17
    v_exp_f32 v18, v18
    v_exp_f32 v19, v19
    v_smfmac_f32_32x32x32_bf16 v[96:111], v[140:143], v[72:79], v144
    ds_read_b128 v[120:123], v145 offset:26624
    s_mov_b64 exec, s[46:47]
    ds_read_b128 v[136:139], v146 offset:58368
    ds_read_b128 v[140:143], v146 offset:58880
    s_mov_b64 exec, -1
    v_exp_f32 v20, v20
    v_exp_f32 v21, v21
    v_exp_f32 v22, v22
    v_exp_f32 v23, v23
    v_exp_f32 v24, v24
    v_mfma_f32_32x32x16_bf16 v[64:79], v[124:127], v[116:119], 0
    v_exp_f32 v25, v25
    v_exp_f32 v26, v26
    v_exp_f32 v27, v27
    v_exp_f32 v28, v28
    v_exp_f32 v29, v29
    v_smfmac_f32_32x32x32_bf16 v[80:95], v[128:131], v[16:23], v144
    v_exp_f32 v30, v30
    v_exp_f32 v31, v31
    v_exp_f32 v32, v32
    v_exp_f32 v33, v33
    v_exp_f32 v34, v34
    v_smfmac_f32_32x32x32_bf16 v[80:95], v[132:135], v[24:31], v144
    v_exp_f32 v35, v35
    v_exp_f32 v36, v36
    v_exp_f32 v37, v37
    v_exp_f32 v38, v38
    v_exp_f32 v39, v39
    v_exp_f32 v40, v40
    v_exp_f32 v41, v41
    v_smfmac_f32_32x32x32_bf16 v[96:111], v[128:131], v[32:39], v144
    v_exp_f32 v42, v42
    v_exp_f32 v43, v43
    v_exp_f32 v44, v44
    v_exp_f32 v45, v45
    v_exp_f32 v46, v46
    v_exp_f32 v47, v47
    s_waitcnt lgkmcnt(0)
    v_mfma_f32_32x32x16_bf16 v[16:31], v[120:123], v[112:115], 0
    v_exp_f32 v48, v48
    v_exp_f32 v49, v49
    v_exp_f32 v50, v50
    v_exp_f32 v51, v51
    v_smfmac_f32_32x32x32_bf16 v[96:111], v[132:135], v[40:47], v144
    ds_read_b128 v[124:127], v145 offset:27648
    s_mov_b64 exec, s[46:47]
    ds_read_b128 v[128:131], v146 offset:59392
    ds_read_b128 v[132:135], v146 offset:59904
    s_mov_b64 exec, -1
    v_exp_f32 v52, v52
    v_exp_f32 v53, v53
    v_exp_f32 v54, v54
    v_exp_f32 v55, v55
    v_exp_f32 v56, v56
    v_mfma_f32_32x32x16_bf16 v[32:47], v[120:123], v[116:119], 0
    v_exp_f32 v57, v57
    v_exp_f32 v58, v58
    v_exp_f32 v59, v59
    v_exp_f32 v60, v60
    v_exp_f32 v61, v61
    v_smfmac_f32_32x32x32_bf16 v[80:95], v[136:139], v[48:55], v144
    v_exp_f32 v62, v62
    v_exp_f32 v63, v63
    v_exp_f32 v64, v64
    v_exp_f32 v65, v65
    v_exp_f32 v66, v66
    v_smfmac_f32_32x32x32_bf16 v[80:95], v[140:143], v[56:63], v144
    v_exp_f32 v67, v67
    v_exp_f32 v68, v68
    v_exp_f32 v69, v69
    v_exp_f32 v70, v70
    v_exp_f32 v71, v71
    v_exp_f32 v72, v72
    v_exp_f32 v73, v73
    v_smfmac_f32_32x32x32_bf16 v[96:111], v[136:139], v[64:71], v144
    v_exp_f32 v74, v74
    v_exp_f32 v75, v75
    v_exp_f32 v76, v76
    v_exp_f32 v77, v77
    v_exp_f32 v78, v78
    v_exp_f32 v79, v79
    s_waitcnt lgkmcnt(0)
    v_mfma_f32_32x32x16_bf16 v[48:63], v[124:127], v[112:115], 0
    v_exp_f32 v16, v16
    v_exp_f32 v17, v17
    v_exp_f32 v18, v18
    v_exp_f32 v19, v19
    v_smfmac_f32_32x32x32_bf16 v[96:111], v[140:143], v[72:79], v144
    ds_read_b128 v[120:123], v145 offset:28672
    s_mov_b64 exec, s[46:47]
    ds_read_b128 v[136:139], v146 offset:60416
    ds_read_b128 v[140:143], v146 offset:60928
    s_mov_b64 exec, -1
    v_exp_f32 v20, v20
    v_exp_f32 v21, v21
    v_exp_f32 v22, v22
    v_exp_f32 v23, v23
    v_exp_f32 v24, v24
    v_mfma_f32_32x32x16_bf16 v[64:79], v[124:127], v[116:119], 0
    v_exp_f32 v25, v25
    v_exp_f32 v26, v26
    v_exp_f32 v27, v27
    v_exp_f32 v28, v28
    v_exp_f32 v29, v29
    v_smfmac_f32_32x32x32_bf16 v[80:95], v[128:131], v[16:23], v144
    v_exp_f32 v30, v30
    v_exp_f32 v31, v31
    v_exp_f32 v32, v32
    v_exp_f32 v33, v33
    v_exp_f32 v34, v34
    v_smfmac_f32_32x32x32_bf16 v[80:95], v[132:135], v[24:31], v144
    v_exp_f32 v35, v35
    v_exp_f32 v36, v36
    v_exp_f32 v37, v37
    v_exp_f32 v38, v38
    v_exp_f32 v39, v39
    v_exp_f32 v40, v40
    v_exp_f32 v41, v41
    v_smfmac_f32_32x32x32_bf16 v[96:111], v[128:131], v[32:39], v144
    v_exp_f32 v42, v42
    v_exp_f32 v43, v43
    v_exp_f32 v44, v44
    v_exp_f32 v45, v45
    v_exp_f32 v46, v46
    v_exp_f32 v47, v47
    s_waitcnt lgkmcnt(0)
    v_mfma_f32_32x32x16_bf16 v[16:31], v[120:123], v[112:115], 0
    v_mov_b32 v148, 28
    ds_write_b32 v150, v148
    ds_read_b32 v149, v151
    v_exp_f32 v48, v48
    v_exp_f32 v49, v49
    v_exp_f32 v50, v50
    v_exp_f32 v51, v51
    v_smfmac_f32_32x32x32_bf16 v[96:111], v[132:135], v[40:47], v144
    ds_read_b128 v[124:127], v145 offset:29696
    s_mov_b64 exec, s[46:47]
    ds_read_b128 v[128:131], v146 offset:61440
    ds_read_b128 v[132:135], v146 offset:61952
    s_mov_b64 exec, -1
    v_exp_f32 v52, v52
    v_exp_f32 v53, v53
    v_exp_f32 v54, v54
    v_exp_f32 v55, v55
    v_exp_f32 v56, v56
    v_mfma_f32_32x32x16_bf16 v[32:47], v[120:123], v[116:119], 0
    v_exp_f32 v57, v57
    v_exp_f32 v58, v58
    v_exp_f32 v59, v59
    v_exp_f32 v60, v60
    v_exp_f32 v61, v61
    v_smfmac_f32_32x32x32_bf16 v[80:95], v[136:139], v[48:55], v144
    v_exp_f32 v62, v62
    v_exp_f32 v63, v63
    v_exp_f32 v64, v64
    v_exp_f32 v65, v65
    v_exp_f32 v66, v66
    v_smfmac_f32_32x32x32_bf16 v[80:95], v[140:143], v[56:63], v144
    v_exp_f32 v67, v67
    v_exp_f32 v68, v68
    v_exp_f32 v69, v69
    v_exp_f32 v70, v70
    v_exp_f32 v71, v71
    v_exp_f32 v72, v72
    v_exp_f32 v73, v73
    v_smfmac_f32_32x32x32_bf16 v[96:111], v[136:139], v[64:71], v144
    v_exp_f32 v74, v74
    v_exp_f32 v75, v75
    v_exp_f32 v76, v76
    v_exp_f32 v77, v77
    v_exp_f32 v78, v78
    v_exp_f32 v79, v79
    s_waitcnt lgkmcnt(0)
    v_readfirstlane_b32 s57, v149
    s_add_u32 s57, s57, s30
    s_cmp_gt_u32 s57, 28
    s_setprio 2
    s_cbranch_scc1 AT_PF28
    s_setprio 1
AT_PF28:
    v_mfma_f32_32x32x16_bf16 v[48:63], v[124:127], v[112:115], 0
    v_exp_f32 v16, v16
    v_exp_f32 v17, v17
    v_exp_f32 v18, v18
    v_exp_f32 v19, v19
    v_smfmac_f32_32x32x32_bf16 v[96:111], v[140:143], v[72:79], v144
    ds_read_b128 v[120:123], v145 offset:30720
    s_mov_b64 exec, s[46:47]
    ds_read_b128 v[136:139], v146 offset:62464
    ds_read_b128 v[140:143], v146 offset:62976
    s_mov_b64 exec, -1
    v_exp_f32 v20, v20
    v_exp_f32 v21, v21
    v_exp_f32 v22, v22
    v_exp_f32 v23, v23
    v_exp_f32 v24, v24
    v_mfma_f32_32x32x16_bf16 v[64:79], v[124:127], v[116:119], 0
    v_exp_f32 v25, v25
    v_exp_f32 v26, v26
    v_exp_f32 v27, v27
    v_exp_f32 v28, v28
    v_exp_f32 v29, v29
    v_smfmac_f32_32x32x32_bf16 v[80:95], v[128:131], v[16:23], v144
    v_exp_f32 v30, v30
    v_exp_f32 v31, v31
    v_exp_f32 v32, v32
    v_exp_f32 v33, v33
    v_exp_f32 v34, v34
    v_smfmac_f32_32x32x32_bf16 v[80:95], v[132:135], v[24:31], v144
    v_exp_f32 v35, v35
    v_exp_f32 v36, v36
    v_exp_f32 v37, v37
    v_exp_f32 v38, v38
    v_exp_f32 v39, v39
    v_exp_f32 v40, v40
    v_exp_f32 v41, v41
    v_smfmac_f32_32x32x32_bf16 v[96:111], v[128:131], v[32:39], v144
    v_exp_f32 v42, v42
    v_exp_f32 v43, v43
    v_exp_f32 v44, v44
    v_exp_f32 v45, v45
    v_exp_f32 v46, v46
    v_exp_f32 v47, v47
    s_waitcnt lgkmcnt(0)
    v_mfma_f32_32x32x16_bf16 v[16:31], v[120:123], v[112:115], 0
    v_exp_f32 v48, v48
    v_exp_f32 v49, v49
    v_exp_f32 v50, v50
    v_exp_f32 v51, v51
    v_smfmac_f32_32x32x32_bf16 v[96:111], v[132:135], v[40:47], v144
    ds_read_b128 v[124:127], v145 offset:31744
    s_mov_b64 exec, s[46:47]
    ds_read_b128 v[128:131], v146 offset:63488
    ds_read_b128 v[132:135], v146 offset:64000
    s_mov_b64 exec, -1
    v_exp_f32 v52, v52
    v_exp_f32 v53, v53
    v_exp_f32 v54, v54
    v_exp_f32 v55, v55
    v_exp_f32 v56, v56
    v_mfma_f32_32x32x16_bf16 v[32:47], v[120:123], v[116:119], 0
    v_exp_f32 v57, v57
    v_exp_f32 v58, v58
    v_exp_f32 v59, v59
    v_exp_f32 v60, v60
    v_exp_f32 v61, v61
    v_smfmac_f32_32x32x32_bf16 v[80:95], v[136:139], v[48:55], v144
    v_exp_f32 v62, v62
    v_exp_f32 v63, v63
    v_exp_f32 v64, v64
    v_exp_f32 v65, v65
    v_exp_f32 v66, v66
    v_smfmac_f32_32x32x32_bf16 v[80:95], v[140:143], v[56:63], v144
    v_exp_f32 v67, v67
    v_exp_f32 v68, v68
    v_exp_f32 v69, v69
    v_exp_f32 v70, v70
    v_exp_f32 v71, v71
    v_exp_f32 v72, v72
    v_exp_f32 v73, v73
    v_smfmac_f32_32x32x32_bf16 v[96:111], v[136:139], v[64:71], v144
    v_exp_f32 v74, v74
    v_exp_f32 v75, v75
    v_exp_f32 v76, v76
    v_exp_f32 v77, v77
    v_exp_f32 v78, v78
    v_exp_f32 v79, v79
    s_waitcnt lgkmcnt(0)
    v_mfma_f32_32x32x16_bf16 v[48:63], v[124:127], v[112:115], 0
    v_exp_f32 v16, v16
    v_exp_f32 v17, v17
    v_exp_f32 v18, v18
    v_exp_f32 v19, v19
    v_smfmac_f32_32x32x32_bf16 v[96:111], v[140:143], v[72:79], v144
    s_mov_b64 exec, s[46:47]
    ds_read_b128 v[136:139], v146 offset:64512
    ds_read_b128 v[140:143], v146 offset:65024
    s_mov_b64 exec, -1
    v_exp_f32 v20, v20
    v_exp_f32 v21, v21
    v_exp_f32 v22, v22
    v_exp_f32 v23, v23
    v_exp_f32 v24, v24
    v_mfma_f32_32x32x16_bf16 v[64:79], v[124:127], v[116:119], 0
    v_exp_f32 v25, v25
    v_exp_f32 v26, v26
    v_exp_f32 v27, v27
    v_exp_f32 v28, v28
    v_exp_f32 v29, v29
    v_smfmac_f32_32x32x32_bf16 v[80:95], v[128:131], v[16:23], v144
    v_exp_f32 v30, v30
    v_exp_f32 v31, v31
    v_exp_f32 v32, v32
    v_exp_f32 v33, v33
    v_exp_f32 v34, v34
    v_smfmac_f32_32x32x32_bf16 v[80:95], v[132:135], v[24:31], v144
    v_exp_f32 v35, v35
    v_exp_f32 v36, v36
    v_exp_f32 v37, v37
    v_exp_f32 v38, v38
    v_exp_f32 v39, v39
    v_exp_f32 v40, v40
    v_exp_f32 v41, v41
    v_smfmac_f32_32x32x32_bf16 v[96:111], v[128:131], v[32:39], v144
    v_exp_f32 v42, v42
    v_exp_f32 v43, v43
    v_exp_f32 v44, v44
    v_exp_f32 v45, v45
    v_exp_f32 v46, v46
    v_exp_f32 v47, v47
    s_waitcnt lgkmcnt(0)
    v_exp_f32 v48, v48
    v_exp_f32 v49, v49
    v_exp_f32 v50, v50
    v_exp_f32 v51, v51
    v_smfmac_f32_32x32x32_bf16 v[96:111], v[132:135], v[40:47], v144
    v_exp_f32 v52, v52
    v_exp_f32 v53, v53
    v_exp_f32 v54, v54
    v_exp_f32 v55, v55
    v_exp_f32 v56, v56
    v_exp_f32 v57, v57
    v_exp_f32 v58, v58
    v_exp_f32 v59, v59
    v_exp_f32 v60, v60
    v_exp_f32 v61, v61
    v_smfmac_f32_32x32x32_bf16 v[80:95], v[136:139], v[48:55], v144
    v_exp_f32 v62, v62
    v_exp_f32 v63, v63
    v_exp_f32 v64, v64
    v_exp_f32 v65, v65
    v_exp_f32 v66, v66
    v_smfmac_f32_32x32x32_bf16 v[80:95], v[140:143], v[56:63], v144
    v_exp_f32 v67, v67
    v_exp_f32 v68, v68
    v_exp_f32 v69, v69
    v_exp_f32 v70, v70
    v_exp_f32 v71, v71
    v_exp_f32 v72, v72
    v_exp_f32 v73, v73
    v_smfmac_f32_32x32x32_bf16 v[96:111], v[136:139], v[64:71], v144
    v_exp_f32 v74, v74
    v_exp_f32 v75, v75
    v_exp_f32 v76, v76
    v_exp_f32 v77, v77
    v_exp_f32 v78, v78
    v_exp_f32 v79, v79
    s_nop 1
    v_smfmac_f32_32x32x32_bf16 v[96:111], v[140:143], v[72:79], v144
    s_setprio 0
    s_nop 13
    s_mul_i32 s52, s24, 2304
    s_add_u32 s52, s52, 143360
    v_lshlrev_b32 v6, 4, v2
    v_lshlrev_b32 v7, 2, v2
    v_add_u32 v4, s52, v6
    v_add_u32 v5, s52, v7
    s_xor_b32 s53, s24, 4
    s_mul_i32 s53, s53, 2304
    s_add_u32 s53, s53, 143360
    v_add_u32 v8, s53, v6
    v_add_u32 v9, s53, v7
    s_lshl_b32 s55, s28, 3
    s_lshl_b32 s56, s29, 1
    s_add_u32 s55, s55, s56
    s_add_u32 s55, s55, s30
    s_lshl_b32 s55, s55, 5
    s_add_u32 s55, s55, s27
    s_lshl_b32 s56, s55, 2
    s_add_u32 s56, s56, 18882560
    s_lshl_b32 s55, s55, 10
    s_add_u32 s55, s55, 6291456
    v_mov_b32 v148, 0
    v_fma_f32 v148, v80, 0, v148
    v_fma_f32 v148, v81, 0, v148
    v_fma_f32 v148, v82, 0, v148
    v_fma_f32 v148, v83, 0, v148
    v_fma_f32 v148, v84, 0, v148
    v_fma_f32 v148, v85, 0, v148
    v_fma_f32 v148, v86, 0, v148
    v_fma_f32 v148, v87, 0, v148
    v_fma_f32 v148, v96, 0, v148
    v_fma_f32 v148, v97, 0, v148
    v_fma_f32 v148, v98, 0, v148
    v_fma_f32 v148, v99, 0, v148
    v_fma_f32 v148, v100, 0, v148
    v_fma_f32 v148, v101, 0, v148
    v_fma_f32 v148, v102, 0, v148
    v_fma_f32 v148, v103, 0, v148
    s_mov_b32 s48, 0x21800000
    s_mov_b32 s49, 0x5d800000
    v_cmp_u_f32 vcc, v148, v148
    v_cmp_nle_f32 s[50:51], s48, v88
    v_cmp_nge_f32 s[58:59], s49, v88
    s_nop 1
    s_or_b64 vcc, vcc, s[50:51]
    s_or_b64 vcc, vcc, s[58:59]
    v_cmp_nle_f32 s[50:51], s48, v104
    v_cmp_nge_f32 s[58:59], s49, v104
    s_nop 1
    s_or_b64 vcc, vcc, s[50:51]
    s_or_b64 vcc, vcc, s[58:59]
    s_cmp_eq_u64 vcc, 0
    s_cselect_b32 s54, 1, 2
    v_mov_b32 v10, 161824
    s_mov_b32 s58, 0x400000
LW_CVX:
    ds_read_b32 v11, v10
    s_sub_u32 s58, s58, 1
    s_waitcnt lgkmcnt(0)
    v_readfirstlane_b32 s57, v11
    s_cmp_eq_u32 s58, 0
    s_cbranch_scc1 LWD_CVX
    s_cmp_ge_u32 s57, 12
    s_cbranch_scc1 LWD_CVX
    s_sleep 1
    s_branch LW_CVX
LWD_CVX:
    s_cmp_eq_u32 s30, 0
    s_cbranch_scc1 AT_SBC
    ds_write_b128 v4, v[80:83]
    ds_write_b128 v4, v[84:87] offset:1024
    ds_write_b32 v5, v88 offset:2048
    s_nop 1
    v_mov_b32 v80, v96
    v_mov_b32 v81, v97
    v_mov_b32 v82, v98
    v_mov_b32 v83, v99
    v_mov_b32 v84, v100
    v_mov_b32 v85, v101
    v_mov_b32 v86, v102
    v_mov_b32 v87, v103
    v_mov_b32 v88, v104
    s_branch AT_SDC
AT_SBC:
    ds_write_b128 v4, v[96:99]
    ds_write_b128 v4, v[100:103] offset:1024
    ds_write_b32 v5, v104 offset:2048
AT_SDC:
    s_waitcnt lgkmcnt(0)
    s_lshl_b32 s57, s24, 2
    s_add_u32 s57, s57, 161888
    v_mov_b32 v10, s57
    v_mov_b32 v11, s54
    s_mov_b64 exec, 1
    ds_write_b32 v10, v11
    s_mov_b64 exec, -1
    s_xor_b32 s57, s57, 16
    v_mov_b32 v10, s57
    s_mov_b32 s58, 0x400000
AT_XW:
    ds_read_b32 v11, v10
    s_sub_u32 s58, s58, 1
    s_waitcnt lgkmcnt(0)
    v_readfirstlane_b32 s57, v11
    s_cmp_eq_u32 s58, 0
    s_cbranch_scc1 AT_XD
    s_cmp_eq_u32 s57, 0
    s_cbranch_scc1 AT_XW
AT_XD:
    ds_read_b128 v[148:151], v8
    ds_read_b128 v[152:155], v8 offset:1024
    ds_read_b32 v156, v9 offset:2048
    s_or_b32 s54, s54, s57
    s_mov_b32 s59, 0
    s_cmp_eq_u32 s54, 1
    s_cbranch_scc1 AT_BOTH
    v_mov_b32 v10, 1
    v_mov_b32 v11, 161792
    ds_write_b32 v11, v10
    s_waitcnt lgkmcnt(0)
    s_branch AT_FB
AT_BOTH:
    s_waitcnt lgkmcnt(0)
    v_add_f32 v80, v80, v148
    v_add_f32 v81, v81, v149
    v_add_f32 v82, v82, v150
    v_add_f32 v83, v83, v151
    v_add_f32 v84, v84, v152
    v_add_f32 v85, v85, v153
    v_add_f32 v86, v86, v154
    v_add_f32 v87, v87, v155
    v_add_f32 v88, v88, v156
    v_rcp_f32 v148, v88
    s_nop 0
    v_mul_f32 v80, v80, v148
    v_mul_f32 v81, v81, v148
    v_mul_f32 v82, v82, v148
    v_mul_f32 v83, v83, v148
    v_mul_f32 v84, v84, v148
    v_mul_f32 v85, v85, v148
    v_mul_f32 v86, v86, v148
    v_mul_f32 v87, v87, v148
    v_cvt_pk_bf16_f32 v152, v80, v81
    v_cvt_pk_bf16_f32 v153, v82, v83
    v_cvt_pk_bf16_f32 v154, v84, v85
    v_cvt_pk_bf16_f32 v155, v86, v87
    buffer_store_dwordx4 v[152:155], v3, s[12:15], s55 offen sc1
    s_waitcnt vmcnt(0)
    v_mov_b32 v6, s56
    v_mov_b32 v7, s60
    s_mov_b64 exec, 1
    global_store_dword v6, v7, s[62:63] sc1
    s_mov_b64 exec, -1
    s_mov_b32 s59, 1
AT_FB:
    s_barrier
    v_mov_b32 v10, 161792
    ds_read_b32 v11, v10
    s_waitcnt lgkmcnt(0)
    v_readfirstlane_b32 s54, v11
    s_nop 3
    s_cmp_lg_u32 s54, 0
    s_cbranch_scc1 AT_FALLBACK
    s_branch AT_DONE
AT_FALLBACK:
    s_barrier
    v_mov_b32 v158, 0xff800000
    v_mov_b32 v159, 0xff800000
    v_lshlrev_b32 v4, 4, v2
    s_mov_b32 s57, 0
FB_MAX:
    ds_read_b128 v[120:123], v4
    s_waitcnt lgkmcnt(0)
    v_mfma_f32_32x32x16_bf16 v[16:31], v[120:123], v[112:115], 0
    v_mfma_f32_32x32x16_bf16 v[32:47], v[120:123], v[116:119], 0
    s_nop 15
    v_max3_f32 v158, v16, v17, v158
    v_max3_f32 v158, v18, v19, v158
    v_max3_f32 v158, v20, v21, v158
    v_max3_f32 v158, v22, v23, v158
    v_max3_f32 v158, v24, v25, v158
    v_max3_f32 v158, v26, v27, v158
    v_max3_f32 v158, v28, v29, v158
    v_max3_f32 v158, v30, v31, v158
    v_max3_f32 v159, v32, v33, v159
    v_max3_f32 v159, v34, v35, v159
    v_max3_f32 v159, v36, v37, v159
    v_max3_f32 v159, v38, v39, v159
    v_max3_f32 v159, v40, v41, v159
    v_max3_f32 v159, v42, v43, v159
    v_max3_f32 v159, v44, v45, v159
    v_max3_f32 v159, v46, v47, v159
    s_add_u32 s57, s57, 1
    s_cmp_eq_u32 s57, 32
    s_movk_i32 s58, 1024
    s_cselect_b32 s58, 33792, s58
    v_add_u32 v4, s58, v4
    s_cmp_lt_u32 s57, 64
    s_cbranch_scc1 FB_MAX
    v_mov_b32 v5, v158
    s_nop 1
    v_permlane32_swap_b32 v158, v5
    s_nop 1
    v_max_f32 v158, v158, v5
    v_sub_f32 v48, 0, v158
    v_sub_f32 v49, 0, v158
    v_sub_f32 v50, 0, v158
    v_sub_f32 v51, 0, v158
    v_sub_f32 v52, 0, v158
    v_sub_f32 v53, 0, v158
    v_sub_f32 v54, 0, v158
    v_sub_f32 v55, 0, v158
    v_sub_f32 v56, 0, v158
    v_sub_f32 v57, 0, v158
    v_sub_f32 v58, 0, v158
    v_sub_f32 v59, 0, v158
    v_sub_f32 v60, 0, v158
    v_sub_f32 v61, 0, v158
    v_sub_f32 v62, 0, v158
    v_sub_f32 v63, 0, v158
    v_mov_b32 v5, v159
    s_nop 1
    v_permlane32_swap_b32 v159, v5
    s_nop 1
    v_max_f32 v159, v159, v5
    v_sub_f32 v64, 0, v159
    v_sub_f32 v65, 0, v159
    v_sub_f32 v66, 0, v159
    v_sub_f32 v67, 0, v159
    v_sub_f32 v68, 0, v159
    v_sub_f32 v69, 0, v159
    v_sub_f32 v70, 0, v159
    v_sub_f32 v71, 0, v159
    v_sub_f32 v72, 0, v159
    v_sub_f32 v73, 0, v159
    v_sub_f32 v74, 0, v159
    v_sub_f32 v75, 0, v159
    v_sub_f32 v76, 0, v159
    v_sub_f32 v77, 0, v159
    v_sub_f32 v78, 0, v159
    v_sub_f32 v79, 0, v159
    v_mov_b32 v80, 0
    v_mov_b32 v81, 0
    v_mov_b32 v82, 0
    v_mov_b32 v83, 0
    v_mov_b32 v84, 0
    v_mov_b32 v85, 0
    v_mov_b32 v86, 0
    v_mov_b32 v87, 0
    v_mov_b32 v88, 0
    v_mov_b32 v89, 0
    v_mov_b32 v90, 0
    v_mov_b32 v91, 0
    v_mov_b32 v92, 0
    v_mov_b32 v93, 0
    v_mov_b32 v94, 0
    v_mov_b32 v95, 0
    v_mov_b32 v96, 0
    v_mov_b32 v97, 0
    v_mov_b32 v98, 0
    v_mov_b32 v99, 0
    v_mov_b32 v100, 0
    v_mov_b32 v101, 0
    v_mov_b32 v102, 0
    v_mov_b32 v103, 0
    v_mov_b32 v104, 0
    v_mov_b32 v105, 0
    v_mov_b32 v106, 0
    v_mov_b32 v107, 0
    v_mov_b32 v108, 0
    v_mov_b32 v109, 0
    v_mov_b32 v110, 0
    v_mov_b32 v111, 0
    v_mov_b32 v4, v145
    v_mov_b32 v5, v146
    s_mov_b32 s57, 0
FB_MAIN:
    ds_read_b128 v[120:123], v4
    s_mov_b64 exec, s[46:47]
    ds_read_b128 v[128:131], v5 offset:32768
    ds_read_b128 v[132:135], v5 offset:33280
    s_mov_b64 exec, -1
    s_waitcnt lgkmcnt(0)
    v_mfma_f32_32x32x16_bf16 v[16:31], v[120:123], v[112:115], v[48:63]
    v_mfma_f32_32x32x16_bf16 v[32:47], v[120:123], v[116:119], v[64:79]
    s_nop 15
    v_exp_f32 v16, v16
    v_exp_f32 v17, v17
    v_exp_f32 v18, v18
    v_exp_f32 v19, v19
    v_exp_f32 v20, v20
    v_exp_f32 v21, v21
    v_exp_f32 v22, v22
    v_exp_f32 v23, v23
    v_exp_f32 v24, v24
    v_exp_f32 v25, v25
    v_exp_f32 v26, v26
    v_exp_f32 v27, v27
    v_exp_f32 v28, v28
    v_exp_f32 v29, v29
    v_exp_f32 v30, v30
    v_exp_f32 v31, v31
    v_exp_f32 v32, v32
    v_exp_f32 v33, v33
    v_exp_f32 v34, v34
    v_exp_f32 v35, v35
    v_exp_f32 v36, v36
    v_exp_f32 v37, v37
    v_exp_f32 v38, v38
    v_exp_f32 v39, v39
    v_exp_f32 v40, v40
    v_exp_f32 v41, v41
    v_exp_f32 v42, v42
    v_exp_f32 v43, v43
    v_exp_f32 v44, v44
    v_exp_f32 v45, v45
    v_exp_f32 v46, v46
    v_exp_f32 v47, v47
    s_nop 2
    v_smfmac_f32_32x32x32_bf16 v[80:95], v[128:131], v[16:23], v144
    v_smfmac_f32_32x32x32_bf16 v[80:95], v[132:135], v[24:31], v144
    v_smfmac_f32_32x32x32_bf16 v[96:111], v[128:131], v[32:39], v144
    v_smfmac_f32_32x32x32_bf16 v[96:111], v[132:135], v[40:47], v144
    v_add_u32 v4, 1024, v4
    v_add_u32 v5, 1024, v5
    s_add_u32 s57, s57, 1
    s_cmp_lt_u32 s57, 32
    s_cbranch_scc1 FB_MAIN
    s_nop 15
    s_mul_i32 s52, s24, 2304
    s_add_u32 s52, s52, 143360
    v_lshlrev_b32 v6, 4, v2
    v_lshlrev_b32 v7, 2, v2
    v_add_u32 v4, s52, v6
    v_add_u32 v5, s52, v7
    s_xor_b32 s53, s24, 4
    s_mul_i32 s53, s53, 2304
    s_add_u32 s53, s53, 143360
    v_add_u32 v8, s53, v6
    v_add_u32 v9, s53, v7
    s_lshl_b32 s55, s28, 3
    s_lshl_b32 s56, s29, 1
    s_add_u32 s55, s55, s56
    s_add_u32 s55, s55, s30
    s_lshl_b32 s55, s55, 5
    s_add_u32 s55, s55, s27
    s_lshl_b32 s56, s55, 2
    s_add_u32 s56, s56, 18882560
    s_lshl_b32 s55, s55, 10
    s_add_u32 s55, s55, 6291456
    s_barrier
    s_cmp_eq_u32 s30, 0
    s_cbranch_scc1 AT_SBF
    ds_write_b128 v4, v[80:83]
    ds_write_b128 v4, v[84:87] offset:1024
    ds_write_b32 v5, v88 offset:2048
    s_nop 1
    v_mov_b32 v80, v96
    v_mov_b32 v81, v97
    v_mov_b32 v82, v98
    v_mov_b32 v83, v99
    v_mov_b32 v84, v100
    v_mov_b32 v85, v101
    v_mov_b32 v86, v102
    v_mov_b32 v87, v103
    v_mov_b32 v88, v104
    s_branch AT_SDF
AT_SBF:
    ds_write_b128 v4, v[96:99]
    ds_write_b128 v4, v[100:103] offset:1024
    ds_write_b32 v5, v104 offset:2048
AT_SDF:
    s_waitcnt lgkmcnt(0)
    s_barrier
    ds_read_b128 v[148:151], v8
    ds_read_b128 v[152:155], v8 offset:1024
    ds_read_b32 v156, v9 offset:2048
    s_waitcnt lgkmcnt(0)
    s_cmp_eq_u32 s59, 1
    s_cbranch_scc1 AT_FDONE
    v_add_f32 v80, v80, v148
    v_add_f32 v81, v81, v149
    v_add_f32 v82, v82, v150
    v_add_f32 v83, v83, v151
    v_add_f32 v84, v84, v152
    v_add_f32 v85, v85, v153
    v_add_f32 v86, v86, v154
    v_add_f32 v87, v87, v155
    v_add_f32 v88, v88, v156
    v_rcp_f32 v148, v88
    s_nop 0
    v_mul_f32 v80, v80, v148
    v_mul_f32 v81, v81, v148
    v_mul_f32 v82, v82, v148
    v_mul_f32 v83, v83, v148
    v_mul_f32 v84, v84, v148
    v_mul_f32 v85, v85, v148
    v_mul_f32 v86, v86, v148
    v_mul_f32 v87, v87, v148
    v_cvt_pk_bf16_f32 v152, v80, v81
    v_cvt_pk_bf16_f32 v153, v82, v83
    v_cvt_pk_bf16_f32 v154, v84, v85
    v_cvt_pk_bf16_f32 v155, v86, v87
    buffer_store_dwordx4 v[152:155], v3, s[12:15], s55 offen sc1
    s_waitcnt vmcnt(0)
    v_mov_b32 v6, s56
    v_mov_b32 v7, s60
    s_mov_b64 exec, 1
    global_store_dword v6, v7, s[62:63] sc1
    s_mov_b64 exec, -1
AT_FDONE:
    s_barrier
AT_DONE:
    s_cmp_ge_u32 s24, 4
    s_cbranch_scc1 KM_A47_P3
    s_load_dwordx2 s[6:7], s[0:1], 80
    s_lshl_b32 s27, s25, 3
    s_and_b32 s28, s26, 7
    s_add_u32 s27, s27, s28
    s_lshr_b32 s28, s26, 3
    v_lshlrev_b32 v3, 4, v2
    v_add_u32 v6, 131072, v3
    v_lshrrev_b32 v7, 5, v2
    v_bfe_u32 v8, v2, 2, 2
    v_lshl_add_u32 v7, v7, 2, v8
    v_bfe_u32 v9, v2, 4, 1
    v_lshlrev_b32 v9, 1, v9
    v_bfe_u32 v11, v2, 1, 1
    v_add_u32 v9, v9, v11
    s_lshl_b32 s37, s24, 2
    v_add_u32 v9, s37, v9
    v_lshlrev_b32 v8, 2, v8
    v_xor_b32 v9, v9, v8
    v_lshlrev_b32 v7, 8, v7
    v_lshl_add_u32 v7, v9, 4, v7
    v_and_b32 v9, 1, v2
    v_lshl_add_u32 v7, v9, 3, v7
    v_add_u32 v12, 0x10000, v7
    v_and_b32 v10, 31, v2
    v_lshlrev_b32 v10, 11, v10
    v_lshrrev_b32 v9, 5, v2
    v_lshl_add_u32 v10, v9, 3, v10
    s_lshl_b32 s36, s27, 16
    s_lshl_b32 s37, s28, 8
    s_add_u32 s36, s36, s37
    s_lshl_b32 s37, s24, 6
    s_add_u32 s36, s36, s37
    v_add_u32 v10, s36, v10
    s_barrier
    s_barrier
    ds_read_b128 v[32:35], v6 offset:0
    ds_read_b64_tr_b16 v[36:37], v7 offset:0
    ds_read_b64_tr_b16 v[38:39], v7 offset:2048
    ds_read_b128 v[40:43], v6 offset:1024
    ds_read_b64_tr_b16 v[44:45], v7 offset:4096
    ds_read_b64_tr_b16 v[46:47], v7 offset:6144
    ds_read_b128 v[48:51], v6 offset:2048
    ds_read_b64_tr_b16 v[52:53], v7 offset:8192
    ds_read_b64_tr_b16 v[54:55], v7 offset:10240
    ds_read_b128 v[56:59], v6 offset:3072
    ds_read_b64_tr_b16 v[60:61], v7 offset:12288
    ds_read_b64_tr_b16 v[62:63], v7 offset:14336
    s_waitcnt lgkmcnt(9)
    v_mfma_f32_32x32x16_bf16 v[16:31], v[36:39], v[32:35], 0
    ds_read_b128 v[32:35], v6 offset:4096
    ds_read_b64_tr_b16 v[36:37], v7 offset:32768
    ds_read_b64_tr_b16 v[38:39], v7 offset:34816
    s_waitcnt lgkmcnt(9)
    v_mfma_f32_32x32x16_bf16 v[16:31], v[44:47], v[40:43], v[16:31]
    ds_read_b128 v[40:43], v6 offset:5120
    ds_read_b64_tr_b16 v[44:45], v7 offset:36864
    ds_read_b64_tr_b16 v[46:47], v7 offset:38912
    s_waitcnt lgkmcnt(9)
    v_mfma_f32_32x32x16_bf16 v[16:31], v[52:55], v[48:51], v[16:31]
    ds_read_b128 v[48:51], v6 offset:6144
    ds_read_b64_tr_b16 v[52:53], v7 offset:40960
    ds_read_b64_tr_b16 v[54:55], v7 offset:43008
    s_waitcnt lgkmcnt(9)
    v_mfma_f32_32x32x16_bf16 v[16:31], v[60:63], v[56:59], v[16:31]
    ds_read_b128 v[56:59], v6 offset:7168
    ds_read_b64_tr_b16 v[60:61], v7 offset:45056
    ds_read_b64_tr_b16 v[62:63], v7 offset:47104
    s_waitcnt lgkmcnt(9)
    v_mfma_f32_32x32x16_bf16 v[16:31], v[36:39], v[32:35], v[16:31]
    ds_read_b128 v[32:35], v6 offset:8192
    ds_read_b64_tr_b16 v[36:37], v12 offset:0
    ds_read_b64_tr_b16 v[38:39], v12 offset:2048
    s_waitcnt lgkmcnt(9)
    v_mfma_f32_32x32x16_bf16 v[16:31], v[44:47], v[40:43], v[16:31]
    ds_read_b128 v[40:43], v6 offset:9216
    ds_read_b64_tr_b16 v[44:45], v12 offset:4096
    ds_read_b64_tr_b16 v[46:47], v12 offset:6144
    s_waitcnt lgkmcnt(9)
    v_mfma_f32_32x32x16_bf16 v[16:31], v[52:55], v[48:51], v[16:31]
    ds_read_b128 v[48:51], v6 offset:10240
    ds_read_b64_tr_b16 v[52:53], v12 offset:8192
    ds_read_b64_tr_b16 v[54:55], v12 offset:10240
    s_waitcnt lgkmcnt(9)
    v_mfma_f32_32x32x16_bf16 v[16:31], v[60:63], v[56:59], v[16:31]
    ds_read_b128 v[56:59], v6 offset:11264
    ds_read_b64_tr_b16 v[60:61], v12 offset:12288
    ds_read_b64_tr_b16 v[62:63], v12 offset:14336
    s_waitcnt lgkmcnt(9)
    v_mfma_f32_32x32x16_bf16 v[16:31], v[36:39], v[32:35], v[16:31]
    ds_read_b128 v[32:35], v6 offset:12288
    ds_read_b64_tr_b16 v[36:37], v12 offset:32768
    ds_read_b64_tr_b16 v[38:39], v12 offset:34816
    s_waitcnt lgkmcnt(9)
    v_mfma_f32_32x32x16_bf16 v[16:31], v[44:47], v[40:43], v[16:31]
    ds_read_b128 v[40:43], v6 offset:13312
    ds_read_b64_tr_b16 v[44:45], v12 offset:36864
    ds_read_b64_tr_b16 v[46:47], v12 offset:38912
    s_waitcnt lgkmcnt(9)
    v_mfma_f32_32x32x16_bf16 v[16:31], v[52:55], v[48:51], v[16:31]
    ds_read_b128 v[48:51], v6 offset:14336
    ds_read_b64_tr_b16 v[52:53], v12 offset:40960
    ds_read_b64_tr_b16 v[54:55], v12 offset:43008
    s_waitcnt lgkmcnt(9)
    v_mfma_f32_32x32x16_bf16 v[16:31], v[60:63], v[56:59], v[16:31]
    ds_read_b128 v[56:59], v6 offset:15360
    ds_read_b64_tr_b16 v[60:61], v12 offset:45056
    ds_read_b64_tr_b16 v[62:63], v12 offset:47104
    s_waitcnt lgkmcnt(9)
    v_mfma_f32_32x32x16_bf16 v[16:31], v[36:39], v[32:35], v[16:31]
    ds_read_b128 v[32:35], v6 offset:16384
    ds_read_b64_tr_b16 v[36:37], v7 offset:16384
    ds_read_b64_tr_b16 v[38:39], v7 offset:18432
    s_waitcnt lgkmcnt(9)
    v_mfma_f32_32x32x16_bf16 v[16:31], v[44:47], v[40:43], v[16:31]
    ds_read_b128 v[40:43], v6 offset:17408
    ds_read_b64_tr_b16 v[44:45], v7 offset:20480
    ds_read_b64_tr_b16 v[46:47], v7 offset:22528
    s_waitcnt lgkmcnt(9)
    v_mfma_f32_32x32x16_bf16 v[16:31], v[52:55], v[48:51], v[16:31]
    ds_read_b128 v[48:51], v6 offset:18432
    ds_read_b64_tr_b16 v[52:53], v7 offset:24576
    ds_read_b64_tr_b16 v[54:55], v7 offset:26624
    s_waitcnt lgkmcnt(9)
    v_mfma_f32_32x32x16_bf16 v[16:31], v[60:63], v[56:59], v[16:31]
    ds_read_b128 v[56:59], v6 offset:19456
    ds_read_b64_tr_b16 v[60:61], v7 offset:28672
    ds_read_b64_tr_b16 v[62:63], v7 offset:30720
    s_waitcnt lgkmcnt(9)
    v_mfma_f32_32x32x16_bf16 v[16:31], v[36:39], v[32:35], v[16:31]
    ds_read_b128 v[32:35], v6 offset:20480
    ds_read_b64_tr_b16 v[36:37], v7 offset:49152
    ds_read_b64_tr_b16 v[38:39], v7 offset:51200
    s_waitcnt lgkmcnt(9)
    v_mfma_f32_32x32x16_bf16 v[16:31], v[44:47], v[40:43], v[16:31]
    ds_read_b128 v[40:43], v6 offset:21504
    ds_read_b64_tr_b16 v[44:45], v7 offset:53248
    ds_read_b64_tr_b16 v[46:47], v7 offset:55296
    s_waitcnt lgkmcnt(9)
    v_mfma_f32_32x32x16_bf16 v[16:31], v[52:55], v[48:51], v[16:31]
    ds_read_b128 v[48:51], v6 offset:22528
    ds_read_b64_tr_b16 v[52:53], v7 offset:57344
    ds_read_b64_tr_b16 v[54:55], v7 offset:59392
    s_waitcnt lgkmcnt(9)
    v_mfma_f32_32x32x16_bf16 v[16:31], v[60:63], v[56:59], v[16:31]
    ds_read_b128 v[56:59], v6 offset:23552
    ds_read_b64_tr_b16 v[60:61], v7 offset:61440
    ds_read_b64_tr_b16 v[62:63], v7 offset:63488
    s_waitcnt lgkmcnt(9)
    v_mfma_f32_32x32x16_bf16 v[16:31], v[36:39], v[32:35], v[16:31]
    ds_read_b128 v[32:35], v6 offset:24576
    ds_read_b64_tr_b16 v[36:37], v12 offset:16384
    ds_read_b64_tr_b16 v[38:39], v12 offset:18432
    s_waitcnt lgkmcnt(9)
    v_mfma_f32_32x32x16_bf16 v[16:31], v[44:47], v[40:43], v[16:31]
    ds_read_b128 v[40:43], v6 offset:25600
    ds_read_b64_tr_b16 v[44:45], v12 offset:20480
    ds_read_b64_tr_b16 v[46:47], v12 offset:22528
    s_waitcnt lgkmcnt(9)
    v_mfma_f32_32x32x16_bf16 v[16:31], v[52:55], v[48:51], v[16:31]
    ds_read_b128 v[48:51], v6 offset:26624
    ds_read_b64_tr_b16 v[52:53], v12 offset:24576
    ds_read_b64_tr_b16 v[54:55], v12 offset:26624
    s_waitcnt lgkmcnt(9)
    v_mfma_f32_32x32x16_bf16 v[16:31], v[60:63], v[56:59], v[16:31]
    ds_read_b128 v[56:59], v6 offset:27648
    ds_read_b64_tr_b16 v[60:61], v12 offset:28672
    ds_read_b64_tr_b16 v[62:63], v12 offset:30720
    s_waitcnt lgkmcnt(9)
    v_mfma_f32_32x32x16_bf16 v[16:31], v[36:39], v[32:35], v[16:31]
    ds_read_b128 v[32:35], v6 offset:28672
    ds_read_b64_tr_b16 v[36:37], v12 offset:49152
    ds_read_b64_tr_b16 v[38:39], v12 offset:51200
    s_waitcnt lgkmcnt(9)
    v_mfma_f32_32x32x16_bf16 v[16:31], v[44:47], v[40:43], v[16:31]
    ds_read_b128 v[40:43], v6 offset:29696
    ds_read_b64_tr_b16 v[44:45], v12 offset:53248
    ds_read_b64_tr_b16 v[46:47], v12 offset:55296
    s_waitcnt lgkmcnt(9)
    v_mfma_f32_32x32x16_bf16 v[16:31], v[52:55], v[48:51], v[16:31]
    ds_read_b128 v[48:51], v6 offset:30720
    ds_read_b64_tr_b16 v[52:53], v12 offset:57344
    ds_read_b64_tr_b16 v[54:55], v12 offset:59392
    s_waitcnt lgkmcnt(9)
    v_mfma_f32_32x32x16_bf16 v[16:31], v[60:63], v[56:59], v[16:31]
    ds_read_b128 v[56:59], v6 offset:31744
    ds_read_b64_tr_b16 v[60:61], v12 offset:61440
    ds_read_b64_tr_b16 v[62:63], v12 offset:63488
    s_waitcnt lgkmcnt(9)
    v_mfma_f32_32x32x16_bf16 v[16:31], v[36:39], v[32:35], v[16:31]
    s_waitcnt lgkmcnt(6)
    v_mfma_f32_32x32x16_bf16 v[16:31], v[44:47], v[40:43], v[16:31]
    s_waitcnt lgkmcnt(3)
    v_mfma_f32_32x32x16_bf16 v[16:31], v[52:55], v[48:51], v[16:31]
    s_waitcnt lgkmcnt(0)
    v_mfma_f32_32x32x16_bf16 v[16:31], v[60:63], v[56:59], v[16:31]
    s_nop 13
    v_cvt_pk_bf16_f32 v16, v16, v17
    v_cvt_pk_bf16_f32 v17, v18, v19
    v_cvt_pk_bf16_f32 v18, v20, v21
    v_cvt_pk_bf16_f32 v19, v22, v23
    v_cvt_pk_bf16_f32 v20, v24, v25
    v_cvt_pk_bf16_f32 v21, v26, v27
    v_cvt_pk_bf16_f32 v22, v28, v29
    v_cvt_pk_bf16_f32 v23, v30, v31
    global_store_dwordx2 v10, v[16:17], s[6:7] offset:0
    global_store_dwordx2 v10, v[18:19], s[6:7] offset:16
    global_store_dwordx2 v10, v[20:21], s[6:7] offset:32
    global_store_dwordx2 v10, v[22:23], s[6:7] offset:48
    s_endpgm
KM_A47_P3:
    s_load_dwordx2 s[4:5], s[0:1], 16
    s_lshl_b32 s27, s25, 3
    s_and_b32 s28, s26, 7
    s_add_u32 s27, s27, s28
    s_lshr_b32 s28, s26, 3
    s_sub_u32 s23, s24, 4
    v_lshrrev_b32 v4, 4, v2
    v_and_b32 v5, 15, v2
    v_lshlrev_b32 v6, 2, v4
    v_xor_b32 v5, v5, v6
    v_lshlrev_b32 v4, 10, v4
    v_lshl_add_u32 v4, v5, 4, v4
    s_lshl_b32 s34, s23, 16
    s_lshl_b32 s35, s23, 15
    s_lshl_b32 s29, s28, 8
    s_waitcnt lgkmcnt(0)
    s_add_u32 s4, s4, s29
    s_addc_u32 s5, s5, 0
    s_mov_b32 s16, s4
    s_and_b32 s17, s5, 0xffff
    s_sub_u32 s18, 524288, s29
    s_mov_b32 s19, 0x20000
    s_add_u32 m0, s35, 16384
    s_add_u32 s36, s34, 262144
    buffer_load_dwordx4 v4, s[16:19], s36 offen lds
    s_add_u32 m0, s35, 17408
    s_add_u32 s36, s34, 266240
    buffer_load_dwordx4 v4, s[16:19], s36 offen lds
    s_add_u32 m0, s35, 18432
    s_add_u32 s36, s34, 270336
    buffer_load_dwordx4 v4, s[16:19], s36 offen lds
    s_add_u32 m0, s35, 19456
    s_add_u32 s36, s34, 274432
    buffer_load_dwordx4 v4, s[16:19], s36 offen lds
    s_add_u32 m0, s35, 20480
    s_add_u32 s36, s34, 278528
    buffer_load_dwordx4 v4, s[16:19], s36 offen lds
    s_add_u32 m0, s35, 21504
    s_add_u32 s36, s34, 282624
    buffer_load_dwordx4 v4, s[16:19], s36 offen lds
    s_add_u32 m0, s35, 22528
    s_add_u32 s36, s34, 286720
    buffer_load_dwordx4 v4, s[16:19], s36 offen lds
    s_add_u32 m0, s35, 23552
    s_add_u32 s36, s34, 290816
    buffer_load_dwordx4 v4, s[16:19], s36 offen lds
    s_add_u32 m0, s35, 24576
    s_add_u32 s36, s34, 294912
    buffer_load_dwordx4 v4, s[16:19], s36 offen lds
    s_add_u32 m0, s35, 25600
    s_add_u32 s36, s34, 299008
    buffer_load_dwordx4 v4, s[16:19], s36 offen lds
    s_add_u32 m0, s35, 26624
    s_add_u32 s36, s34, 303104
    buffer_load_dwordx4 v4, s[16:19], s36 offen lds
    s_add_u32 m0, s35, 27648
    s_add_u32 s36, s34, 307200
    buffer_load_dwordx4 v4, s[16:19], s36 offen lds
    s_add_u32 m0, s35, 28672
    s_add_u32 s36, s34, 311296
    buffer_load_dwordx4 v4, s[16:19], s36 offen lds
    s_add_u32 m0, s35, 29696
    s_add_u32 s36, s34, 315392
    buffer_load_dwordx4 v4, s[16:19], s36 offen lds
    s_add_u32 m0, s35, 30720
    s_add_u32 s36, s34, 319488
    buffer_load_dwordx4 v4, s[16:19], s36 offen lds
    s_add_u32 m0, s35, 31744
    s_add_u32 s36, s34, 323584
    buffer_load_dwordx4 v4, s[16:19], s36 offen lds
    s_barrier
    s_waitcnt vmcnt(0)
    s_barrier
    s_endpgm
KM_B:
    s_cmp_eq_u32 s24, 11
    s_cbranch_scc1 KM_B3
    s_load_dwordx4 s[4:7], s[0:1], 0
    s_lshr_b32 s27, s25, 1
    s_lshl_b32 s27, s27, 3
    s_and_b32 s28, s26, 7
    s_add_u32 s27, s27, s28
    s_and_b32 s28, s25, 1
    s_lshl_b32 s28, s28, 2
    s_lshr_b32 s29, s26, 3
    s_add_u32 s28, s28, s29
    s_sub_u32 s30, s24, 8
    v_lshrrev_b32 v3, 3, v2
    v_lshlrev_b32 v3, 10, v3
    v_lshrrev_b32 v4, 4, v2
    v_and_b32 v5, 7, v2
    v_xor_b32 v6, v5, v4
    v_xor_b32 v7, 4, v6
    v_lshl_add_u32 v8, v6, 4, v3
    v_lshl_add_u32 v9, v7, 4, v3
    s_lshl_b32 s31, s30, 14
    s_lshl_b32 s34, s30, 11
    s_mul_i32 s35, s30, 192
    v_add_u32 v13, s35, v2
    v_mul_u32_u24 v14, 683, v13
    v_lshrrev_b32 v14, 14, v14
    v_mul_u32_u24 v15, 24, v14
    v_sub_u32 v15, v13, v15
    v_lshrrev_b32 v16, 3, v15
    v_and_b32 v15, 7, v15
    v_bfe_u32 v17, v14, 1, 1
    v_lshlrev_b32 v17, 2, v17
    v_xor_b32 v15, v15, v17
    v_mul_u32_u24 v14, 3072, v14
    v_lshl_add_u32 v14, v16, 10, v14
    v_lshl_add_u32 v10, v15, 4, v14
    v_add_u32 v13, s35, v2
    v_add_u32 v13, 64, v13
    v_mul_u32_u24 v14, 683, v13
    v_lshrrev_b32 v14, 14, v14
    v_mul_u32_u24 v15, 24, v14
    v_sub_u32 v15, v13, v15
    v_lshrrev_b32 v16, 3, v15
    v_and_b32 v15, 7, v15
    v_bfe_u32 v17, v14, 1, 1
    v_lshlrev_b32 v17, 2, v17
    v_xor_b32 v15, v15, v17
    v_mul_u32_u24 v14, 3072, v14
    v_lshl_add_u32 v14, v16, 10, v14
    v_lshl_add_u32 v11, v15, 4, v14
    v_add_u32 v13, s35, v2
    v_add_u32 v13, 128, v13
    v_mul_u32_u24 v14, 683, v13
    v_lshrrev_b32 v14, 14, v14
    v_mul_u32_u24 v15, 24, v14
    v_sub_u32 v15, v13, v15
    v_lshrrev_b32 v16, 3, v15
    v_and_b32 v15, 7, v15
    v_bfe_u32 v17, v14, 1, 1
    v_lshlrev_b32 v17, 2, v17
    v_xor_b32 v15, v15, v17
    v_mul_u32_u24 v14, 3072, v14
    v_lshl_add_u32 v14, v16, 10, v14
    v_lshl_add_u32 v12, v15, 4, v14
    s_mul_i32 s35, s30, 3072
    s_add_u32 s35, s35, 24576
    s_lshl_b32 s29, s27, 16
    s_lshl_b32 s33, s28, 7
    s_waitcnt lgkmcnt(0)
    s_add_u32 s4, s4, s29
    s_addc_u32 s5, s5, 0
    s_mov_b32 s12, s4
    s_and_b32 s13, s5, 0xffff
    s_mov_b32 s14, 65536
    s_mov_b32 s15, 0x20000
    s_add_u32 s6, s6, s33
    s_addc_u32 s7, s7, 0
    s_mov_b32 s16, s6
    s_and_b32 s17, s7, 0xffff
    s_sub_u32 s18, 1572864, s33
    s_mov_b32 s19, 0x20000
    s_and_b32 s20, s26, 7
    s_add_u32 s21, s20, 0
    s_and_b32 s21, s21, 7
    s_lshl_b32 s21, s21, 7
    s_add_u32 s21, s21, s31
    s_add_u32 m0, s34, 0
    s_add_u32 s32, s21, 0
    buffer_load_dwordx4 v8, s[12:15], s32 offen lds
    s_add_u32 m0, s34, 1024
    s_add_u32 s32, s21, 8192
    buffer_load_dwordx4 v9, s[12:15], s32 offen lds
    s_lshl_b32 s33, s20, 1
    s_add_u32 s33, s33, 0
    s_and_b32 s33, s33, 15
    s_mul_i32 s33, s33, 98304
    s_add_u32 m0, s35, 0
    s_nop 0
    buffer_load_dwordx4 v10, s[16:19], s33 offen lds
    s_add_u32 m0, s35, 1024
    s_nop 0
    buffer_load_dwordx4 v11, s[16:19], s33 offen lds
    s_add_u32 m0, s35, 2048
    s_nop 0
    buffer_load_dwordx4 v12, s[16:19], s33 offen lds
    s_lshl_b32 s33, s20, 1
    s_add_u32 s33, s33, 1
    s_and_b32 s33, s33, 15
    s_mul_i32 s33, s33, 98304
    s_add_u32 m0, s35, 12288
    s_nop 0
    buffer_load_dwordx4 v10, s[16:19], s33 offen lds
    s_add_u32 m0, s35, 13312
    s_nop 0
    buffer_load_dwordx4 v11, s[16:19], s33 offen lds
    s_add_u32 m0, s35, 14336
    s_nop 0
    buffer_load_dwordx4 v12, s[16:19], s33 offen lds
    s_add_u32 s21, s20, 1
    s_and_b32 s21, s21, 7
    s_lshl_b32 s21, s21, 7
    s_add_u32 s21, s21, s31
    s_add_u32 m0, s34, 8192
    s_add_u32 s32, s21, 0
    buffer_load_dwordx4 v8, s[12:15], s32 offen lds
    s_add_u32 m0, s34, 9216
    s_add_u32 s32, s21, 8192
    buffer_load_dwordx4 v9, s[12:15], s32 offen lds
    s_lshl_b32 s33, s20, 1
    s_add_u32 s33, s33, 2
    s_and_b32 s33, s33, 15
    s_mul_i32 s33, s33, 98304
    s_add_u32 m0, s35, 24576
    s_nop 0
    buffer_load_dwordx4 v10, s[16:19], s33 offen lds
    s_add_u32 m0, s35, 25600
    s_nop 0
    buffer_load_dwordx4 v11, s[16:19], s33 offen lds
    s_add_u32 m0, s35, 26624
    s_nop 0
    buffer_load_dwordx4 v12, s[16:19], s33 offen lds
    s_waitcnt vmcnt(8)
    s_barrier
    s_lshl_b32 s33, s20, 1
    s_add_u32 s33, s33, 3
    s_and_b32 s33, s33, 15
    s_mul_i32 s33, s33, 98304
    s_add_u32 m0, s35, 36864
    s_nop 0
    buffer_load_dwordx4 v10, s[16:19], s33 offen lds
    s_add_u32 m0, s35, 37888
    s_nop 0
    buffer_load_dwordx4 v11, s[16:19], s33 offen lds
    s_add_u32 m0, s35, 38912
    s_nop 0
    buffer_load_dwordx4 v12, s[16:19], s33 offen lds
    s_add_u32 s21, s20, 2
    s_and_b32 s21, s21, 7
    s_lshl_b32 s21, s21, 7
    s_add_u32 s21, s21, s31
    s_add_u32 m0, s34, 16384
    s_add_u32 s32, s21, 0
    buffer_load_dwordx4 v8, s[12:15], s32 offen lds
    s_add_u32 m0, s34, 17408
    s_add_u32 s32, s21, 8192
    buffer_load_dwordx4 v9, s[12:15], s32 offen lds
    s_lshl_b32 s33, s20, 1
    s_add_u32 s33, s33, 4
    s_and_b32 s33, s33, 15
    s_mul_i32 s33, s33, 98304
    s_add_u32 m0, s35, 49152
    s_nop 0
    buffer_load_dwordx4 v10, s[16:19], s33 offen lds
    s_add_u32 m0, s35, 50176
    s_nop 0
    buffer_load_dwordx4 v11, s[16:19], s33 offen lds
    s_add_u32 m0, s35, 51200
    s_nop 0
    buffer_load_dwordx4 v12, s[16:19], s33 offen lds
    s_waitcnt vmcnt(13)
    s_barrier
    s_lshl_b32 s33, s20, 1
    s_add_u32 s33, s33, 5
    s_and_b32 s33, s33, 15
    s_mul_i32 s33, s33, 98304
    s_add_u32 m0, s35, 0
    s_nop 0
    buffer_load_dwordx4 v10, s[16:19], s33 offen lds
    s_add_u32 m0, s35, 1024
    s_nop 0
    buffer_load_dwordx4 v11, s[16:19], s33 offen lds
    s_add_u32 m0, s35, 2048
    s_nop 0
    buffer_load_dwordx4 v12, s[16:19], s33 offen lds
    s_waitcnt vmcnt(11)
    s_barrier
    s_add_u32 s21, s20, 3
    s_and_b32 s21, s21, 7
    s_lshl_b32 s21, s21, 7
    s_add_u32 s21, s21, s31
    s_add_u32 m0, s34, 0
    s_add_u32 s32, s21, 0
    buffer_load_dwordx4 v8, s[12:15], s32 offen lds
    s_add_u32 m0, s34, 1024
    s_add_u32 s32, s21, 8192
    buffer_load_dwordx4 v9, s[12:15], s32 offen lds
    s_lshl_b32 s33, s20, 1
    s_add_u32 s33, s33, 6
    s_and_b32 s33, s33, 15
    s_mul_i32 s33, s33, 98304
    s_add_u32 m0, s35, 12288
    s_nop 0
    buffer_load_dwordx4 v10, s[16:19], s33 offen lds
    s_add_u32 m0, s35, 13312
    s_nop 0
    buffer_load_dwordx4 v11, s[16:19], s33 offen lds
    s_add_u32 m0, s35, 14336
    s_nop 0
    buffer_load_dwordx4 v12, s[16:19], s33 offen lds
    s_waitcnt vmcnt(13)
    s_barrier
    s_lshl_b32 s33, s20, 1
    s_add_u32 s33, s33, 7
    s_and_b32 s33, s33, 15
    s_mul_i32 s33, s33, 98304
    s_add_u32 m0, s35, 24576
    s_nop 0
    buffer_load_dwordx4 v10, s[16:19], s33 offen lds
    s_add_u32 m0, s35, 25600
    s_nop 0
    buffer_load_dwordx4 v11, s[16:19], s33 offen lds
    s_add_u32 m0, s35, 26624
    s_nop 0
    buffer_load_dwordx4 v12, s[16:19], s33 offen lds
    s_waitcnt vmcnt(11)
    s_barrier
    s_add_u32 s21, s20, 4
    s_and_b32 s21, s21, 7
    s_lshl_b32 s21, s21, 7
    s_add_u32 s21, s21, s31
    s_add_u32 m0, s34, 8192
    s_add_u32 s32, s21, 0
    buffer_load_dwordx4 v8, s[12:15], s32 offen lds
    s_add_u32 m0, s34, 9216
    s_add_u32 s32, s21, 8192
    buffer_load_dwordx4 v9, s[12:15], s32 offen lds
    s_lshl_b32 s33, s20, 1
    s_add_u32 s33, s33, 8
    s_and_b32 s33, s33, 15
    s_mul_i32 s33, s33, 98304
    s_add_u32 m0, s35, 36864
    s_nop 0
    buffer_load_dwordx4 v10, s[16:19], s33 offen lds
    s_add_u32 m0, s35, 37888
    s_nop 0
    buffer_load_dwordx4 v11, s[16:19], s33 offen lds
    s_add_u32 m0, s35, 38912
    s_nop 0
    buffer_load_dwordx4 v12, s[16:19], s33 offen lds
    s_waitcnt vmcnt(13)
    s_barrier
    s_lshl_b32 s33, s20, 1
    s_add_u32 s33, s33, 9
    s_and_b32 s33, s33, 15
    s_mul_i32 s33, s33, 98304
    s_add_u32 m0, s35, 49152
    s_nop 0
    buffer_load_dwordx4 v10, s[16:19], s33 offen lds
    s_add_u32 m0, s35, 50176
    s_nop 0
    buffer_load_dwordx4 v11, s[16:19], s33 offen lds
    s_add_u32 m0, s35, 51200
    s_nop 0
    buffer_load_dwordx4 v12, s[16:19], s33 offen lds
    s_waitcnt vmcnt(11)
    s_barrier
    s_add_u32 s21, s20, 5
    s_and_b32 s21, s21, 7
    s_lshl_b32 s21, s21, 7
    s_add_u32 s21, s21, s31
    s_add_u32 m0, s34, 16384
    s_add_u32 s32, s21, 0
    buffer_load_dwordx4 v8, s[12:15], s32 offen lds
    s_add_u32 m0, s34, 17408
    s_add_u32 s32, s21, 8192
    buffer_load_dwordx4 v9, s[12:15], s32 offen lds
    s_lshl_b32 s33, s20, 1
    s_add_u32 s33, s33, 10
    s_and_b32 s33, s33, 15
    s_mul_i32 s33, s33, 98304
    s_add_u32 m0, s35, 0
    s_nop 0
    buffer_load_dwordx4 v10, s[16:19], s33 offen lds
    s_add_u32 m0, s35, 1024
    s_nop 0
    buffer_load_dwordx4 v11, s[16:19], s33 offen lds
    s_add_u32 m0, s35, 2048
    s_nop 0
    buffer_load_dwordx4 v12, s[16:19], s33 offen lds
    s_waitcnt vmcnt(13)
    s_barrier
    s_lshl_b32 s33, s20, 1
    s_add_u32 s33, s33, 11
    s_and_b32 s33, s33, 15
    s_mul_i32 s33, s33, 98304
    s_add_u32 m0, s35, 12288
    s_nop 0
    buffer_load_dwordx4 v10, s[16:19], s33 offen lds
    s_add_u32 m0, s35, 13312
    s_nop 0
    buffer_load_dwordx4 v11, s[16:19], s33 offen lds
    s_add_u32 m0, s35, 14336
    s_nop 0
    buffer_load_dwordx4 v12, s[16:19], s33 offen lds
    s_waitcnt vmcnt(11)
    s_barrier
    s_add_u32 s21, s20, 6
    s_and_b32 s21, s21, 7
    s_lshl_b32 s21, s21, 7
    s_add_u32 s21, s21, s31
    s_add_u32 m0, s34, 0
    s_add_u32 s32, s21, 0
    buffer_load_dwordx4 v8, s[12:15], s32 offen lds
    s_add_u32 m0, s34, 1024
    s_add_u32 s32, s21, 8192
    buffer_load_dwordx4 v9, s[12:15], s32 offen lds
    s_lshl_b32 s33, s20, 1
    s_add_u32 s33, s33, 12
    s_and_b32 s33, s33, 15
    s_mul_i32 s33, s33, 98304
    s_add_u32 m0, s35, 24576
    s_nop 0
    buffer_load_dwordx4 v10, s[16:19], s33 offen lds
    s_add_u32 m0, s35, 25600
    s_nop 0
    buffer_load_dwordx4 v11, s[16:19], s33 offen lds
    s_add_u32 m0, s35, 26624
    s_nop 0
    buffer_load_dwordx4 v12, s[16:19], s33 offen lds
    s_waitcnt vmcnt(13)
    s_barrier
    s_lshl_b32 s33, s20, 1
    s_add_u32 s33, s33, 13
    s_and_b32 s33, s33, 15
    s_mul_i32 s33, s33, 98304
    s_add_u32 m0, s35, 36864
    s_nop 0
    buffer_load_dwordx4 v10, s[16:19], s33 offen lds
    s_add_u32 m0, s35, 37888
    s_nop 0
    buffer_load_dwordx4 v11, s[16:19], s33 offen lds
    s_add_u32 m0, s35, 38912
    s_nop 0
    buffer_load_dwordx4 v12, s[16:19], s33 offen lds
    s_waitcnt vmcnt(11)
    s_barrier
    s_add_u32 s21, s20, 7
    s_and_b32 s21, s21, 7
    s_lshl_b32 s21, s21, 7
    s_add_u32 s21, s21, s31
    s_add_u32 m0, s34, 8192
    s_add_u32 s32, s21, 0
    buffer_load_dwordx4 v8, s[12:15], s32 offen lds
    s_add_u32 m0, s34, 9216
    s_add_u32 s32, s21, 8192
    buffer_load_dwordx4 v9, s[12:15], s32 offen lds
    s_lshl_b32 s33, s20, 1
    s_add_u32 s33, s33, 14
    s_and_b32 s33, s33, 15
    s_mul_i32 s33, s33, 98304
    s_add_u32 m0, s35, 49152
    s_nop 0
    buffer_load_dwordx4 v10, s[16:19], s33 offen lds
    s_add_u32 m0, s35, 50176
    s_nop 0
    buffer_load_dwordx4 v11, s[16:19], s33 offen lds
    s_add_u32 m0, s35, 51200
    s_nop 0
    buffer_load_dwordx4 v12, s[16:19], s33 offen lds
    s_waitcnt vmcnt(13)
    s_barrier
    s_lshl_b32 s33, s20, 1
    s_add_u32 s33, s33, 15
    s_and_b32 s33, s33, 15
    s_mul_i32 s33, s33, 98304
    s_add_u32 m0, s35, 0
    s_nop 0
    buffer_load_dwordx4 v10, s[16:19], s33 offen lds
    s_add_u32 m0, s35, 1024
    s_nop 0
    buffer_load_dwordx4 v11, s[16:19], s33 offen lds
    s_add_u32 m0, s35, 2048
    s_nop 0
    buffer_load_dwordx4 v12, s[16:19], s33 offen lds
    s_waitcnt vmcnt(11)
    s_barrier
    s_waitcnt vmcnt(8)
    s_barrier
    s_waitcnt vmcnt(3)
    s_barrier
    s_waitcnt vmcnt(0)
    s_barrier
    s_barrier
    s_branch KM_NOUT
KM_B3:
    s_load_dwordx4 s[4:7], s[0:1], 0
    s_lshr_b32 s27, s25, 1
    s_lshl_b32 s27, s27, 3
    s_and_b32 s28, s26, 7
    s_add_u32 s27, s27, s28
    s_and_b32 s28, s25, 1
    s_lshl_b32 s28, s28, 2
    s_lshr_b32 s29, s26, 3
    s_add_u32 s28, s28, s29
    s_sub_u32 s30, s24, 8
    v_lshrrev_b32 v3, 3, v2
    v_lshlrev_b32 v3, 10, v3
    v_lshrrev_b32 v4, 4, v2
    v_and_b32 v5, 7, v2
    v_xor_b32 v6, v5, v4
    v_xor_b32 v7, 4, v6
    v_lshl_add_u32 v8, v6, 4, v3
    v_lshl_add_u32 v9, v7, 4, v3
    s_lshl_b32 s31, s30, 14
    s_lshl_b32 s34, s30, 11
    s_mul_i32 s35, s30, 192
    v_add_u32 v13, s35, v2
    v_mul_u32_u24 v14, 683, v13
    v_lshrrev_b32 v14, 14, v14
    v_mul_u32_u24 v15, 24, v14
    v_sub_u32 v15, v13, v15
    v_lshrrev_b32 v16, 3, v15
    v_and_b32 v15, 7, v15
    v_bfe_u32 v17, v14, 1, 1
    v_lshlrev_b32 v17, 2, v17
    v_xor_b32 v15, v15, v17
    v_mul_u32_u24 v14, 3072, v14
    v_lshl_add_u32 v14, v16, 10, v14
    v_lshl_add_u32 v10, v15, 4, v14
    v_add_u32 v13, s35, v2
    v_add_u32 v13, 64, v13
    v_mul_u32_u24 v14, 683, v13
    v_lshrrev_b32 v14, 14, v14
    v_mul_u32_u24 v15, 24, v14
    v_sub_u32 v15, v13, v15
    v_lshrrev_b32 v16, 3, v15
    v_and_b32 v15, 7, v15
    v_bfe_u32 v17, v14, 1, 1
    v_lshlrev_b32 v17, 2, v17
    v_xor_b32 v15, v15, v17
    v_mul_u32_u24 v14, 3072, v14
    v_lshl_add_u32 v14, v16, 10, v14
    v_lshl_add_u32 v11, v15, 4, v14
    v_add_u32 v13, s35, v2
    v_add_u32 v13, 128, v13
    v_mul_u32_u24 v14, 683, v13
    v_lshrrev_b32 v14, 14, v14
    v_mul_u32_u24 v15, 24, v14
    v_sub_u32 v15, v13, v15
    v_lshrrev_b32 v16, 3, v15
    v_and_b32 v15, 7, v15
    v_bfe_u32 v17, v14, 1, 1
    v_lshlrev_b32 v17, 2, v17
    v_xor_b32 v15, v15, v17
    v_mul_u32_u24 v14, 3072, v14
    v_lshl_add_u32 v14, v16, 10, v14
    v_lshl_add_u32 v12, v15, 4, v14
    s_mul_i32 s35, s30, 3072
    s_add_u32 s35, s35, 24576
    s_lshl_b32 s29, s27, 16
    s_lshl_b32 s33, s28, 7
    s_waitcnt lgkmcnt(0)
    s_add_u32 s4, s4, s29
    s_addc_u32 s5, s5, 0
    s_mov_b32 s12, s4
    s_and_b32 s13, s5, 0xffff
    s_mov_b32 s14, 65536
    s_mov_b32 s15, 0x20000
    s_add_u32 s6, s6, s33
    s_addc_u32 s7, s7, 0
    s_mov_b32 s16, s6
    s_and_b32 s17, s7, 0xffff
    s_sub_u32 s18, 1572864, s33
    s_mov_b32 s19, 0x20000
    s_load_dwordx2 s[42:43], s[0:1], 24
    s_and_b32 s36, s26, 3
    s_lshr_b32 s37, s26, 2
    v_and_b32 v60, 7, v2
    v_lshrrev_b32 v61, 3, v2
    s_lshl_b32 s38, s37, 8
    s_lshl_b32 s39, s36, 3
    s_add_u32 s38, s38, s39
    v_lshlrev_b32 v62, 5, v61
    v_add_u32 v62, s38, v62
    v_lshlrev_b32 v62, 10, v62
    s_lshl_b32 s38, s25, 7
    v_lshl_add_u32 v62, v60, 4, v62
    v_add_u32 v62, s38, v62
    v_add_u32 v63, 0x1000, v62
    s_lshl_b32 s38, s25, 18
    s_lshl_b32 s39, s36, 10
    s_add_u32 s38, s38, s39
    s_lshl_b32 s39, s37, 7
    s_add_u32 s38, s38, s39
    s_add_u32 s38, s38, 8388608
    v_lshlrev_b32 v56, 15, v61
    v_lshl_add_u32 v56, v60, 4, v56
    v_add_u32 v56, s38, v56
    v_lshlrev_b32 v57, 7, v60
    v_lshl_add_u32 v57, v61, 4, v57
    v_add_u32 v57, 24576, v57
    v_lshlrev_b32 v58, 4, v2
    v_add_u32 v58, 24576, v58
    s_waitcnt lgkmcnt(0)
    s_mov_b32 s40, 0x05040100
    s_mov_b32 s41, 0x07060302
    s_and_b32 s20, s26, 7
    s_add_u32 s21, s20, 0
    s_and_b32 s21, s21, 7
    s_lshl_b32 s21, s21, 7
    s_add_u32 s21, s21, s31
    s_add_u32 m0, s34, 0
    s_add_u32 s32, s21, 0
    buffer_load_dwordx4 v8, s[12:15], s32 offen lds
    s_add_u32 m0, s34, 1024
    s_add_u32 s32, s21, 8192
    buffer_load_dwordx4 v9, s[12:15], s32 offen lds
    s_lshl_b32 s33, s20, 1
    s_add_u32 s33, s33, 0
    s_and_b32 s33, s33, 15
    s_mul_i32 s33, s33, 98304
    s_add_u32 m0, s35, 0
    s_nop 0
    buffer_load_dwordx4 v10, s[16:19], s33 offen lds
    s_add_u32 m0, s35, 1024
    s_nop 0
    buffer_load_dwordx4 v11, s[16:19], s33 offen lds
    s_add_u32 m0, s35, 2048
    s_nop 0
    buffer_load_dwordx4 v12, s[16:19], s33 offen lds
    s_lshl_b32 s33, s20, 1
    s_add_u32 s33, s33, 1
    s_and_b32 s33, s33, 15
    s_mul_i32 s33, s33, 98304
    s_add_u32 m0, s35, 12288
    s_nop 0
    buffer_load_dwordx4 v10, s[16:19], s33 offen lds
    s_add_u32 m0, s35, 13312
    s_nop 0
    buffer_load_dwordx4 v11, s[16:19], s33 offen lds
    s_add_u32 m0, s35, 14336
    s_nop 0
    buffer_load_dwordx4 v12, s[16:19], s33 offen lds
    s_add_u32 s21, s20, 1
    s_and_b32 s21, s21, 7
    s_lshl_b32 s21, s21, 7
    s_add_u32 s21, s21, s31
    s_add_u32 m0, s34, 8192
    s_add_u32 s32, s21, 0
    buffer_load_dwordx4 v8, s[12:15], s32 offen lds
    s_add_u32 m0, s34, 9216
    s_add_u32 s32, s21, 8192
    buffer_load_dwordx4 v9, s[12:15], s32 offen lds
    s_lshl_b32 s33, s20, 1
    s_add_u32 s33, s33, 2
    s_and_b32 s33, s33, 15
    s_mul_i32 s33, s33, 98304
    s_add_u32 m0, s35, 24576
    s_nop 0
    buffer_load_dwordx4 v10, s[16:19], s33 offen lds
    s_add_u32 m0, s35, 25600
    s_nop 0
    buffer_load_dwordx4 v11, s[16:19], s33 offen lds
    s_add_u32 m0, s35, 26624
    s_nop 0
    buffer_load_dwordx4 v12, s[16:19], s33 offen lds
    s_waitcnt vmcnt(8)
    s_barrier
    s_lshl_b32 s33, s20, 1
    s_add_u32 s33, s33, 3
    s_and_b32 s33, s33, 15
    s_mul_i32 s33, s33, 98304
    s_add_u32 m0, s35, 36864
    s_nop 0
    buffer_load_dwordx4 v10, s[16:19], s33 offen lds
    s_add_u32 m0, s35, 37888
    s_nop 0
    buffer_load_dwordx4 v11, s[16:19], s33 offen lds
    s_add_u32 m0, s35, 38912
    s_nop 0
    buffer_load_dwordx4 v12, s[16:19], s33 offen lds
    s_add_u32 s21, s20, 2
    s_and_b32 s21, s21, 7
    s_lshl_b32 s21, s21, 7
    s_add_u32 s21, s21, s31
    s_add_u32 m0, s34, 16384
    s_add_u32 s32, s21, 0
    buffer_load_dwordx4 v8, s[12:15], s32 offen lds
    s_add_u32 m0, s34, 17408
    s_add_u32 s32, s21, 8192
    buffer_load_dwordx4 v9, s[12:15], s32 offen lds
    s_lshl_b32 s33, s20, 1
    s_add_u32 s33, s33, 4
    s_and_b32 s33, s33, 15
    s_mul_i32 s33, s33, 98304
    s_add_u32 m0, s35, 49152
    s_nop 0
    buffer_load_dwordx4 v10, s[16:19], s33 offen lds
    s_add_u32 m0, s35, 50176
    s_nop 0
    buffer_load_dwordx4 v11, s[16:19], s33 offen lds
    s_add_u32 m0, s35, 51200
    s_nop 0
    buffer_load_dwordx4 v12, s[16:19], s33 offen lds
    s_waitcnt vmcnt(13)
    s_barrier
    s_lshl_b32 s33, s20, 1
    s_add_u32 s33, s33, 5
    s_and_b32 s33, s33, 15
    s_mul_i32 s33, s33, 98304
    s_add_u32 m0, s35, 0
    s_nop 0
    buffer_load_dwordx4 v10, s[16:19], s33 offen lds
    s_add_u32 m0, s35, 1024
    s_nop 0
    buffer_load_dwordx4 v11, s[16:19], s33 offen lds
    s_add_u32 m0, s35, 2048
    s_nop 0
    buffer_load_dwordx4 v12, s[16:19], s33 offen lds
    global_load_dwordx4 v[96:99], v62, s[42:43] offset:0
    global_load_dwordx4 v[100:103], v62, s[42:43] offset:1024
    global_load_dwordx4 v[104:107], v62, s[42:43] offset:2048
    global_load_dwordx4 v[108:111], v62, s[42:43] offset:3072
    global_load_dwordx4 v[112:115], v63, s[42:43] offset:0
    global_load_dwordx4 v[116:119], v63, s[42:43] offset:1024
    global_load_dwordx4 v[120:123], v63, s[42:43] offset:2048
    global_load_dwordx4 v[124:127], v63, s[42:43] offset:3072
    s_waitcnt vmcnt(19)
    s_barrier
    s_add_u32 s21, s20, 3
    s_and_b32 s21, s21, 7
    s_lshl_b32 s21, s21, 7
    s_add_u32 s21, s21, s31
    s_add_u32 m0, s34, 0
    s_add_u32 s32, s21, 0
    buffer_load_dwordx4 v8, s[12:15], s32 offen lds
    s_add_u32 m0, s34, 1024
    s_add_u32 s32, s21, 8192
    buffer_load_dwordx4 v9, s[12:15], s32 offen lds
    s_lshl_b32 s33, s20, 1
    s_add_u32 s33, s33, 6
    s_and_b32 s33, s33, 15
    s_mul_i32 s33, s33, 98304
    s_add_u32 m0, s35, 12288
    s_nop 0
    buffer_load_dwordx4 v10, s[16:19], s33 offen lds
    s_add_u32 m0, s35, 13312
    s_nop 0
    buffer_load_dwordx4 v11, s[16:19], s33 offen lds
    s_add_u32 m0, s35, 14336
    s_nop 0
    buffer_load_dwordx4 v12, s[16:19], s33 offen lds
    s_waitcnt vmcnt(21)
    s_barrier
    s_lshl_b32 s33, s20, 1
    s_add_u32 s33, s33, 7
    s_and_b32 s33, s33, 15
    s_mul_i32 s33, s33, 98304
    s_add_u32 m0, s35, 24576
    s_nop 0
    buffer_load_dwordx4 v10, s[16:19], s33 offen lds
    s_add_u32 m0, s35, 25600
    s_nop 0
    buffer_load_dwordx4 v11, s[16:19], s33 offen lds
    s_add_u32 m0, s35, 26624
    s_nop 0
    buffer_load_dwordx4 v12, s[16:19], s33 offen lds
    s_waitcnt vmcnt(19)
    s_barrier
    s_add_u32 s21, s20, 4
    s_and_b32 s21, s21, 7
    s_lshl_b32 s21, s21, 7
    s_add_u32 s21, s21, s31
    s_add_u32 m0, s34, 8192
    s_add_u32 s32, s21, 0
    buffer_load_dwordx4 v8, s[12:15], s32 offen lds
    s_add_u32 m0, s34, 9216
    s_add_u32 s32, s21, 8192
    buffer_load_dwordx4 v9, s[12:15], s32 offen lds
    s_lshl_b32 s33, s20, 1
    s_add_u32 s33, s33, 8
    s_and_b32 s33, s33, 15
    s_mul_i32 s33, s33, 98304
    s_add_u32 m0, s35, 36864
    s_nop 0
    buffer_load_dwordx4 v10, s[16:19], s33 offen lds
    s_add_u32 m0, s35, 37888
    s_nop 0
    buffer_load_dwordx4 v11, s[16:19], s33 offen lds
    s_add_u32 m0, s35, 38912
    s_nop 0
    buffer_load_dwordx4 v12, s[16:19], s33 offen lds
    s_waitcnt vmcnt(21)
    s_barrier
    s_lshl_b32 s33, s20, 1
    s_add_u32 s33, s33, 9
    s_and_b32 s33, s33, 15
    s_mul_i32 s33, s33, 98304
    s_add_u32 m0, s35, 49152
    s_nop 0
    buffer_load_dwordx4 v10, s[16:19], s33 offen lds
    s_add_u32 m0, s35, 50176
    s_nop 0
    buffer_load_dwordx4 v11, s[16:19], s33 offen lds
    s_add_u32 m0, s35, 51200
    s_nop 0
    buffer_load_dwordx4 v12, s[16:19], s33 offen lds
    s_waitcnt vmcnt(11)
    s_barrier
    s_add_u32 s21, s20, 5
    s_and_b32 s21, s21, 7
    s_lshl_b32 s21, s21, 7
    s_add_u32 s21, s21, s31
    s_add_u32 m0, s34, 16384
    s_add_u32 s32, s21, 0
    buffer_load_dwordx4 v8, s[12:15], s32 offen lds
    s_add_u32 m0, s34, 17408
    s_add_u32 s32, s21, 8192
    buffer_load_dwordx4 v9, s[12:15], s32 offen lds
    s_lshl_b32 s33, s20, 1
    s_add_u32 s33, s33, 10
    s_and_b32 s33, s33, 15
    s_mul_i32 s33, s33, 98304
    s_add_u32 m0, s35, 0
    s_nop 0
    buffer_load_dwordx4 v10, s[16:19], s33 offen lds
    s_add_u32 m0, s35, 1024
    s_nop 0
    buffer_load_dwordx4 v11, s[16:19], s33 offen lds
    s_add_u32 m0, s35, 2048
    s_nop 0
    buffer_load_dwordx4 v12, s[16:19], s33 offen lds
    s_waitcnt vmcnt(13)
    s_barrier
    s_lshl_b32 s33, s20, 1
    s_add_u32 s33, s33, 11
    s_and_b32 s33, s33, 15
    s_mul_i32 s33, s33, 98304
    s_add_u32 m0, s35, 12288
    s_nop 0
    buffer_load_dwordx4 v10, s[16:19], s33 offen lds
    s_add_u32 m0, s35, 13312
    s_nop 0
    buffer_load_dwordx4 v11, s[16:19], s33 offen lds
    s_add_u32 m0, s35, 14336
    s_nop 0
    buffer_load_dwordx4 v12, s[16:19], s33 offen lds
    s_waitcnt vmcnt(11)
    s_barrier
    s_add_u32 s21, s20, 6
    s_and_b32 s21, s21, 7
    s_lshl_b32 s21, s21, 7
    s_add_u32 s21, s21, s31
    s_add_u32 m0, s34, 0
    s_add_u32 s32, s21, 0
    buffer_load_dwordx4 v8, s[12:15], s32 offen lds
    s_add_u32 m0, s34, 1024
    s_add_u32 s32, s21, 8192
    buffer_load_dwordx4 v9, s[12:15], s32 offen lds
    s_lshl_b32 s33, s20, 1
    s_add_u32 s33, s33, 12
    s_and_b32 s33, s33, 15
    s_mul_i32 s33, s33, 98304
    s_add_u32 m0, s35, 24576
    s_nop 0
    buffer_load_dwordx4 v10, s[16:19], s33 offen lds
    s_add_u32 m0, s35, 25600
    s_nop 0
    buffer_load_dwordx4 v11, s[16:19], s33 offen lds
    s_add_u32 m0, s35, 26624
    s_nop 0
    buffer_load_dwordx4 v12, s[16:19], s33 offen lds
    s_waitcnt vmcnt(13)
    s_barrier
    s_lshl_b32 s33, s20, 1
    s_add_u32 s33, s33, 13
    s_and_b32 s33, s33, 15
    s_mul_i32 s33, s33, 98304
    s_add_u32 m0, s35, 36864
    s_nop 0
    buffer_load_dwordx4 v10, s[16:19], s33 offen lds
    s_add_u32 m0, s35, 37888
    s_nop 0
    buffer_load_dwordx4 v11, s[16:19], s33 offen lds
    s_add_u32 m0, s35, 38912
    s_nop 0
    buffer_load_dwordx4 v12, s[16:19], s33 offen lds
    s_waitcnt vmcnt(11)
    s_barrier
    s_add_u32 s21, s20, 7
    s_and_b32 s21, s21, 7
    s_lshl_b32 s21, s21, 7
    s_add_u32 s21, s21, s31
    s_add_u32 m0, s34, 8192
    s_add_u32 s32, s21, 0
    buffer_load_dwordx4 v8, s[12:15], s32 offen lds
    s_add_u32 m0, s34, 9216
    s_add_u32 s32, s21, 8192
    buffer_load_dwordx4 v9, s[12:15], s32 offen lds
    s_lshl_b32 s33, s20, 1
    s_add_u32 s33, s33, 14
    s_and_b32 s33, s33, 15
    s_mul_i32 s33, s33, 98304
    s_add_u32 m0, s35, 49152
    s_nop 0
    buffer_load_dwordx4 v10, s[16:19], s33 offen lds
    s_add_u32 m0, s35, 50176
    s_nop 0
    buffer_load_dwordx4 v11, s[16:19], s33 offen lds
    s_add_u32 m0, s35, 51200
    s_nop 0
    buffer_load_dwordx4 v12, s[16:19], s33 offen lds
    s_waitcnt vmcnt(13)
    s_barrier
    s_lshl_b32 s33, s20, 1
    s_add_u32 s33, s33, 15
    s_and_b32 s33, s33, 15
    s_mul_i32 s33, s33, 98304
    s_add_u32 m0, s35, 0
    s_nop 0
    buffer_load_dwordx4 v10, s[16:19], s33 offen lds
    s_add_u32 m0, s35, 1024
    s_nop 0
    buffer_load_dwordx4 v11, s[16:19], s33 offen lds
    s_add_u32 m0, s35, 2048
    s_nop 0
    buffer_load_dwordx4 v12, s[16:19], s33 offen lds
    s_waitcnt vmcnt(11)
    s_barrier
    s_waitcnt vmcnt(8)
    s_barrier
    s_waitcnt vmcnt(3)
    s_barrier
    s_waitcnt vmcnt(0)
    s_barrier
    s_barrier
    s_load_dwordx2 s[50:51], s[0:1], 88
    v_mov_b32 v5, 0
    s_waitcnt lgkmcnt(0)
    global_load_dword v59, v5, s[50:51] sc1
    s_waitcnt vmcnt(0)
    v_perm_b32 v64, v120, v124, s40
    v_perm_b32 v65, v112, v116, s40
    v_perm_b32 v66, v104, v108, s40
    v_perm_b32 v67, v96, v100, s40
    ds_write_b128 v57, v[64:67] offset:0
    v_perm_b32 v68, v120, v124, s41
    v_perm_b32 v69, v112, v116, s41
    v_perm_b32 v70, v104, v108, s41
    v_perm_b32 v71, v96, v100, s41
    ds_write_b128 v57, v[68:71] offset:1024
    v_perm_b32 v72, v121, v125, s40
    v_perm_b32 v73, v113, v117, s40
    v_perm_b32 v74, v105, v109, s40
    v_perm_b32 v75, v97, v101, s40
    ds_write_b128 v57, v[72:75] offset:2048
    v_perm_b32 v76, v121, v125, s41
    v_perm_b32 v77, v113, v117, s41
    v_perm_b32 v78, v105, v109, s41
    v_perm_b32 v79, v97, v101, s41
    ds_write_b128 v57, v[76:79] offset:3072
    v_perm_b32 v64, v122, v126, s40
    v_perm_b32 v65, v114, v118, s40
    v_perm_b32 v66, v106, v110, s40
    v_perm_b32 v67, v98, v102, s40
    ds_write_b128 v57, v[64:67] offset:4096
    v_perm_b32 v68, v122, v126, s41
    v_perm_b32 v69, v114, v118, s41
    v_perm_b32 v70, v106, v110, s41
    v_perm_b32 v71, v98, v102, s41
    ds_write_b128 v57, v[68:71] offset:5120
    v_perm_b32 v72, v123, v127, s40
    v_perm_b32 v73, v115, v119, s40
    v_perm_b32 v74, v107, v111, s40
    v_perm_b32 v75, v99, v103, s40
    ds_write_b128 v57, v[72:75] offset:6144
    v_perm_b32 v76, v123, v127, s41
    v_perm_b32 v77, v115, v119, s41
    v_perm_b32 v78, v107, v111, s41
    v_perm_b32 v79, v99, v103, s41
    ds_write_b128 v57, v[76:79] offset:7168
    s_waitcnt lgkmcnt(0)
    ds_read_b128 v[96:99], v58 offset:0
    ds_read_b128 v[100:103], v58 offset:1024
    ds_read_b128 v[104:107], v58 offset:2048
    ds_read_b128 v[108:111], v58 offset:3072
    ds_read_b128 v[112:115], v58 offset:4096
    ds_read_b128 v[116:119], v58 offset:5120
    ds_read_b128 v[120:123], v58 offset:6144
    ds_read_b128 v[124:127], v58 offset:7168
    s_waitcnt lgkmcnt(7)
    global_store_dwordx4 v56, v[96:99], s[62:63] sc1
    v_add_u32 v56, 0x1000, v56
    s_waitcnt lgkmcnt(6)
    global_store_dwordx4 v56, v[100:103], s[62:63] sc1
    v_add_u32 v56, 0x1000, v56
    s_waitcnt lgkmcnt(5)
    global_store_dwordx4 v56, v[104:107], s[62:63] sc1
    v_add_u32 v56, 0x1000, v56
    s_waitcnt lgkmcnt(4)
    global_store_dwordx4 v56, v[108:111], s[62:63] sc1
    v_add_u32 v56, 0x1000, v56
    s_waitcnt lgkmcnt(3)
    global_store_dwordx4 v56, v[112:115], s[62:63] sc1
    v_add_u32 v56, 0x1000, v56
    s_waitcnt lgkmcnt(2)
    global_store_dwordx4 v56, v[116:119], s[62:63] sc1
    v_add_u32 v56, 0x1000, v56
    s_waitcnt lgkmcnt(1)
    global_store_dwordx4 v56, v[120:123], s[62:63] sc1
    v_add_u32 v56, 0x1000, v56
    s_waitcnt lgkmcnt(0)
    global_store_dwordx4 v56, v[124:127], s[62:63] sc1
    s_mov_b32 s39, 0x100000
    s_waitcnt vmcnt(0)
UT_NON:
    v_readfirstlane_b32 s60, v59
    s_sub_u32 s39, s39, 1
    s_cmp_lg_u32 s60, 0
    s_cbranch_scc1 UT_NOND
    s_cmp_eq_u32 s39, 0
    s_cbranch_scc1 UT_NOND
    global_load_dword v59, v5, s[50:51] sc1
    s_waitcnt vmcnt(0)
    s_branch UT_NON
UT_NOND:
    s_lshl_b32 s51, s25, 5
    s_add_u32 s51, s51, s26
    s_lshl_b32 s51, s51, 2
    s_add_u32 s51, s51, 18878464
    v_mov_b32 v6, s51
    v_mov_b32 v7, s60
    s_mov_b64 exec, 1
    global_store_dword v6, v7, s[62:63] sc1
    s_mov_b64 exec, -1
KM_NOUT:
    s_sub_u32 s27, s24, 8
    s_lshr_b32 s28, s27, 1
    s_and_b32 s29, s27, 1
    s_lshl_b32 s30, s25, 6
    s_lshl_b32 s31, s26, 1
    s_add_u32 s30, s30, s31
    s_add_u32 s30, s30, s28
    v_lshlrev_b32 v3, 4, v2
    s_lshl_b32 s45, s25, 2
    s_and_b32 s47, s26, 3
    s_add_u32 s45, s45, s47
    s_lshl_b32 s45, s45, 6
    s_lshl_b32 s47, s28, 5
    s_add_u32 s46, s45, s47
    s_lshl_b32 s46, s46, 10
    s_mul_i32 s47, s29, 2097152
    s_add_u32 s46, s46, s47
    s_add_u32 s46, s46, 2097152
    s_lshl_b32 s47, s28, 16
    s_lshl_b32 s48, s29, 15
    s_add_u32 s47, s47, s48
    s_lshr_b32 s49, s26, 2
    s_lshl_b32 s49, s49, 3
    s_add_u32 s49, s49, s45
    s_lshl_b32 s50, s27, 1
    s_add_u32 s49, s49, s50
    s_lshl_b32 s49, s49, 10
    s_lshl_b32 s50, s27, 11
    s_add_u32 s50, s50, 152064
    s_mov_b32 s12, s62
    s_and_b32 s13, s63, 0xffff
    s_mov_b32 s14, 17825792
    s_mov_b32 s15, 0x20000
    s_cmp_lg_u32 s27, 0
    s_cbranch_scc1 B_W1
    v_mov_b32 v4, 161808
    s_mov_b32 s52, 0x400000
LW_ST1:
    ds_read_b32 v5, v4
    s_sub_u32 s52, s52, 1
    s_waitcnt lgkmcnt(0)
    v_readfirstlane_b32 s51, v5
    s_cmp_eq_u32 s52, 0
    s_cbranch_scc1 LWD_ST1
    s_cmp_ge_u32 s51, 4
    s_cbranch_scc1 LWD_ST1
    s_sleep 1
    s_branch LW_ST1
LWD_ST1:
    v_mov_b32 v4, 161820
    ds_read_b32 v5, v4
    s_waitcnt lgkmcnt(0)
    v_readfirstlane_b32 s60, v5
    s_nop 3
    s_lshl_b32 s51, s25, 7
    s_add_u32 s51, s51, 18878464
    v_and_b32 v4, 31, v2
    v_lshlrev_b32 v4, 2, v4
    v_add_u32 v4, s51, v4
    s_mov_b32 s52, 0x100000
GP_E2:
    global_load_dword v5, v4, s[62:63] sc1
    s_sub_u32 s52, s52, 1
    s_waitcnt vmcnt(0)
    v_cmp_eq_u32 vcc, s60, v5
    s_cmp_eq_u32 s52, 0
    s_cbranch_scc1 GPD_E2
    s_cmp_eq_u64 vcc, exec
    s_cbranch_scc0 GP_E2
GPD_E2:
    s_lshl_b32 s51, s25, 1
    s_bfe_u32 s52, s26, 0x10001
    s_add_u32 s51, s51, s52
    s_lshl_b32 s51, s51, 8
    s_add_u32 s51, s51, 18874368
    v_and_b32 v4, 63, v2
    v_lshlrev_b32 v4, 2, v4
    v_add_u32 v4, s51, v4
    s_mov_b32 s52, 0x100000
GP_E1:
    global_load_dword v5, v4, s[62:63] sc1
    s_sub_u32 s52, s52, 1
    s_waitcnt vmcnt(0)
    v_cmp_eq_u32 vcc, s60, v5
    s_cmp_eq_u32 s52, 0
    s_cbranch_scc1 GPD_E1
    s_cmp_eq_u64 vcc, exec
    s_cbranch_scc0 GP_E1
GPD_E1:
    v_mov_b32 v4, 161804
    v_mov_b32 v5, 1
    s_mov_b64 exec, 1
    ds_write_b32 v4, v5
    s_mov_b64 exec, -1
    s_branch B_G1
B_W1:
    v_mov_b32 v4, 161804
    s_mov_b32 s52, 0x400000
LW_F1:
    ds_read_b32 v5, v4
    s_sub_u32 s52, s52, 1
    s_waitcnt lgkmcnt(0)
    v_readfirstlane_b32 s51, v5
    s_cmp_eq_u32 s52, 0
    s_cbranch_scc1 LWD_F1
    s_cmp_ge_u32 s51, 1
    s_cbranch_scc1 LWD_F1
    s_sleep 1
    s_branch LW_F1
LWD_F1:
B_G1:
    s_mov_b32 m0, s50
    s_add_u32 s51, s49, 1024
    buffer_load_dwordx4 v3, s[12:15], s49 offen sc1 lds
    s_add_u32 m0, s50, 1024
    s_nop 0
    buffer_load_dwordx4 v3, s[12:15], s51 offen sc1 lds
    s_mov_b32 m0, s47
    s_add_u32 s47, s47, 1024
    buffer_load_dwordx4 v3, s[12:15], s46 offen sc1 lds
    s_add_u32 s46, s46, 1024
    s_mov_b32 m0, s47
    s_add_u32 s47, s47, 1024
    buffer_load_dwordx4 v3, s[12:15], s46 offen sc1 lds
    s_add_u32 s46, s46, 1024
    s_mov_b32 m0, s47
    s_add_u32 s47, s47, 1024
    buffer_load_dwordx4 v3, s[12:15], s46 offen sc1 lds
    s_add_u32 s46, s46, 1024
    s_mov_b32 m0, s47
    s_add_u32 s47, s47, 1024
    buffer_load_dwordx4 v3, s[12:15], s46 offen sc1 lds
    s_add_u32 s46, s46, 1024
    s_mov_b32 m0, s47
    s_add_u32 s47, s47, 1024
    buffer_load_dwordx4 v3, s[12:15], s46 offen sc1 lds
    s_add_u32 s46, s46, 1024
    s_mov_b32 m0, s47
    s_add_u32 s47, s47, 1024
    buffer_load_dwordx4 v3, s[12:15], s46 offen sc1 lds
    s_add_u32 s46, s46, 1024
    s_mov_b32 m0, s47
    s_add_u32 s47, s47, 1024
    buffer_load_dwordx4 v3, s[12:15], s46 offen sc1 lds
    s_add_u32 s46, s46, 1024
    s_lshl_b32 s31, s30, 12
    s_add_u32 s31, s31, 8388608
    s_lshl_b32 s32, s29, 11
    s_add_u32 s31, s31, s32
    s_mul_i32 s33, s28, 6144
    s_add_u32 s33, s33, 131072
    s_mul_i32 s34, s29, 3072
    s_add_u32 s34, s34, s33
    s_add_u32 m0, s34, 512
    s_add_u32 s35, s31, 1024
    buffer_load_dwordx4 v3, s[12:15], s31 offen sc1 lds
    s_add_u32 m0, s34, 2048
    s_nop 0
    buffer_load_dwordx4 v3, s[12:15], s35 offen sc1 lds
    s_waitcnt vmcnt(6)
    s_barrier
    s_waitcnt vmcnt(2)
    s_waitcnt lgkmcnt(0)
    v_mov_b32 v16, 161828
    v_mov_b32 v17, 1
    s_mov_b64 exec, 1
    ds_add_u32 v16, v17
    s_mov_b64 exec, -1
    s_mov_b32 m0, s47
    s_add_u32 s47, s47, 1024
    buffer_load_dwordx4 v3, s[12:15], s46 offen sc1 lds
    s_add_u32 s46, s46, 1024
    s_mov_b32 m0, s47
    s_add_u32 s47, s47, 1024
    buffer_load_dwordx4 v3, s[12:15], s46 offen sc1 lds
    s_add_u32 s46, s46, 1024
    s_mov_b32 m0, s47
    s_add_u32 s47, s47, 1024
    buffer_load_dwordx4 v3, s[12:15], s46 offen sc1 lds
    s_add_u32 s46, s46, 1024
    s_mov_b32 m0, s47
    s_add_u32 s47, s47, 1024
    buffer_load_dwordx4 v3, s[12:15], s46 offen sc1 lds
    s_add_u32 s46, s46, 1024
    s_mov_b32 m0, s47
    s_add_u32 s47, s47, 1024
    buffer_load_dwordx4 v3, s[12:15], s46 offen sc1 lds
    s_add_u32 s46, s46, 1024
    s_mov_b32 m0, s47
    s_add_u32 s47, s47, 1024
    buffer_load_dwordx4 v3, s[12:15], s46 offen sc1 lds
    s_add_u32 s46, s46, 1024
    s_mov_b32 m0, s47
    s_add_u32 s47, s47, 1024
    buffer_load_dwordx4 v3, s[12:15], s46 offen sc1 lds
    s_add_u32 s46, s46, 1024
    s_mov_b32 m0, s47
    s_add_u32 s47, s47, 1024
    buffer_load_dwordx4 v3, s[12:15], s46 offen sc1 lds
    s_add_u32 s46, s46, 1024
    s_mov_b32 m0, s47
    s_add_u32 s47, s47, 1024
    buffer_load_dwordx4 v3, s[12:15], s46 offen sc1 lds
    s_add_u32 s46, s46, 1024
    s_mov_b32 m0, s47
    s_add_u32 s47, s47, 1024
    buffer_load_dwordx4 v3, s[12:15], s46 offen sc1 lds
    s_add_u32 s46, s46, 1024
    s_mov_b32 m0, s47
    s_add_u32 s47, s47, 1024
    buffer_load_dwordx4 v3, s[12:15], s46 offen sc1 lds
    s_add_u32 s46, s46, 1024
    s_mov_b32 m0, s47
    s_add_u32 s47, s47, 1024
    buffer_load_dwordx4 v3, s[12:15], s46 offen sc1 lds
    s_add_u32 s46, s46, 1024
    s_mov_b32 m0, s47
    s_add_u32 s47, s47, 1024
    buffer_load_dwordx4 v3, s[12:15], s46 offen sc1 lds
    s_add_u32 s46, s46, 1024
    s_mov_b32 m0, s47
    s_add_u32 s47, s47, 1024
    buffer_load_dwordx4 v3, s[12:15], s46 offen sc1 lds
    s_add_u32 s46, s46, 1024
    s_mov_b32 m0, s47
    s_add_u32 s47, s47, 1024
    buffer_load_dwordx4 v3, s[12:15], s46 offen sc1 lds
    s_add_u32 s46, s46, 1024
    s_mov_b32 m0, s47
    s_add_u32 s47, s47, 1024
    buffer_load_dwordx4 v3, s[12:15], s46 offen sc1 lds
    s_add_u32 s46, s46, 1024
    s_mov_b32 m0, s47
    s_add_u32 s47, s47, 1024
    buffer_load_dwordx4 v3, s[12:15], s46 offen sc1 lds
    s_add_u32 s46, s46, 1024
    s_mov_b32 m0, s47
    s_add_u32 s47, s47, 1024
    buffer_load_dwordx4 v3, s[12:15], s46 offen sc1 lds
    s_add_u32 s46, s46, 1024
    s_mov_b32 m0, s47
    s_add_u32 s47, s47, 1024
    buffer_load_dwordx4 v3, s[12:15], s46 offen sc1 lds
    s_add_u32 s46, s46, 1024
    s_mov_b32 m0, s47
    s_add_u32 s47, s47, 1024
    buffer_load_dwordx4 v3, s[12:15], s46 offen sc1 lds
    s_add_u32 s46, s46, 1024
    s_mov_b32 m0, s47
    s_add_u32 s47, s47, 1024
    buffer_load_dwordx4 v3, s[12:15], s46 offen sc1 lds
    s_add_u32 s46, s46, 1024
    s_mov_b32 m0, s47
    s_add_u32 s47, s47, 1024
    buffer_load_dwordx4 v3, s[12:15], s46 offen sc1 lds
    s_add_u32 s46, s46, 1024
    s_mov_b32 m0, s47
    s_add_u32 s47, s47, 1024
    buffer_load_dwordx4 v3, s[12:15], s46 offen sc1 lds
    s_add_u32 s46, s46, 1024
    s_mov_b32 m0, s47
    s_add_u32 s47, s47, 1024
    buffer_load_dwordx4 v3, s[12:15], s46 offen sc1 lds
    s_add_u32 s46, s46, 1024
    s_mov_b32 m0, s47
    s_add_u32 s47, s47, 1024
    buffer_load_dwordx4 v3, s[12:15], s46 offen sc1 lds
    s_add_u32 s46, s46, 1024
    s_load_dwordx2 s[4:5], s[0:1], 72
    v_and_b32 v4, 31, v2
    v_lshrrev_b32 v5, 5, v2
    v_mul_u32_u24 v6, 1536, v5
    v_lshl_add_u32 v6, v4, 4, v6
    v_add_u32 v6, s34, v6
    v_mov_b32 v8, 0
    v_mov_b32 v9, 0
    v_mov_b32 v10, 0
    v_mov_b32 v11, 0
    ds_write_b128 v6, v[8:11]
    s_mul_i32 s35, s30, 8448
    s_add_u32 s35, s35, 10485760
    s_add_u32 s36, s62, s35
    s_addc_u32 s37, s63, 0
    v_and_b32 v7, 15, v4
    v_lshlrev_b32 v12, 1, v7
    v_lshl_add_u32 v12, v5, 3, v12
    v_lshrrev_b32 v7, 4, v4
    v_lshl_add_u32 v12, v7, 1, v12
    v_lshlrev_b32 v12, 1, v12
    v_xor_b32 v7, 1, v7
    v_mul_u32_u24 v7, 4224, v7
    v_add_u32 v12, v12, v7
    s_lshl_b32 s38, s30, 1
    v_mov_b32 v7, s38
    s_waitcnt lgkmcnt(0)
    global_load_ushort v13, v7, s[4:5]
    s_waitcnt vmcnt(0) lgkmcnt(0)
    v_lshlrev_b32 v13, 16, v13
    s_waitcnt lgkmcnt(0)
    v_mov_b32 v16, 161816
    v_mov_b32 v17, 1
    s_mov_b64 exec, 1
    ds_add_u32 v16, v17
    s_mov_b64 exec, -1
    s_setprio 3
    v_mov_b32 v16, 161816
    s_mov_b32 s52, 0x400000
LW_STG4:
    ds_read_b32 v17, v16
    s_sub_u32 s52, s52, 1
    s_waitcnt lgkmcnt(0)
    v_readfirstlane_b32 s51, v17
    s_cmp_eq_u32 s52, 0
    s_cbranch_scc1 LWD_STG4
    s_cmp_ge_u32 s51, 4
    s_cbranch_scc1 LWD_STG4
    s_sleep 1
    s_branch LW_STG4
LWD_STG4:
    s_setprio 1
    s_cmp_eq_u32 s29, 0
    s_cbranch_scc0 CV_Y
    v_sub_u32 v7, 3, v5
    v_mul_u32_u24 v14, 1536, v7
    v_lshl_add_u32 v14, v4, 4, v14
    v_add_u32 v14, s33, v14
    v_add_u32 v14, 16, v14
    v_subrev_u32 v15, 3072, v14
    global_load_dwordx4 v[48:51], v12, s[36:37] offset:0
    global_load_dwordx4 v[52:55], v12, s[36:37] offset:32
    global_load_dwordx4 v[56:59], v12, s[36:37] offset:64
    global_load_dwordx4 v[60:63], v12, s[36:37] offset:96
    global_load_dwordx4 v[64:67], v12, s[36:37] offset:128
    global_load_dwordx4 v[68:71], v12, s[36:37] offset:160
    ds_read_b128 v[104:107], v14 offset:496
    ds_read_b128 v[108:111], v15 offset:496
    ds_read_b128 v[112:115], v14 offset:480
    global_load_dwordx4 v[72:75], v12, s[36:37] offset:192
    ds_read_b128 v[116:119], v15 offset:480
    s_waitcnt vmcnt(6) lgkmcnt(3)
    v_mfma_f32_32x32x16_bf16 v[16:31], v[48:51], v[104:107], 0
    global_load_dwordx4 v[76:79], v12, s[36:37] offset:224
    ds_read_b128 v[104:107], v14 offset:464
    s_waitcnt vmcnt(6) lgkmcnt(3)
    v_mfma_f32_32x32x16_bf16 v[16:31], v[52:55], v[108:111], v[16:31]
    global_load_dwordx4 v[48:51], v12, s[36:37] offset:256
    ds_read_b128 v[108:111], v15 offset:464
    s_waitcnt vmcnt(6) lgkmcnt(3)
    v_mfma_f32_32x32x16_bf16 v[16:31], v[56:59], v[112:115], v[16:31]
    global_load_dwordx4 v[52:55], v12, s[36:37] offset:288
    ds_read_b128 v[112:115], v14 offset:448
    s_waitcnt vmcnt(6) lgkmcnt(3)
    v_mfma_f32_32x32x16_bf16 v[16:31], v[60:63], v[116:119], v[16:31]
    global_load_dwordx4 v[56:59], v12, s[36:37] offset:320
    ds_read_b128 v[116:119], v15 offset:448
    s_waitcnt vmcnt(6) lgkmcnt(3)
    v_mfma_f32_32x32x16_bf16 v[16:31], v[64:67], v[104:107], v[16:31]
    global_load_dwordx4 v[60:63], v12, s[36:37] offset:352
    ds_read_b128 v[104:107], v14 offset:432
    s_waitcnt vmcnt(6) lgkmcnt(3)
    v_mfma_f32_32x32x16_bf16 v[16:31], v[68:71], v[108:111], v[16:31]
    global_load_dwordx4 v[64:67], v12, s[36:37] offset:384
    ds_read_b128 v[108:111], v15 offset:432
    s_waitcnt vmcnt(6) lgkmcnt(3)
    v_mfma_f32_32x32x16_bf16 v[16:31], v[72:75], v[112:115], v[16:31]
    global_load_dwordx4 v[68:71], v12, s[36:37] offset:416
    ds_read_b128 v[112:115], v14 offset:416
    s_waitcnt vmcnt(6) lgkmcnt(3)
    v_mfma_f32_32x32x16_bf16 v[16:31], v[76:79], v[116:119], v[16:31]
    global_load_dwordx4 v[72:75], v12, s[36:37] offset:448
    ds_read_b128 v[116:119], v15 offset:416
    s_waitcnt vmcnt(6) lgkmcnt(3)
    v_mfma_f32_32x32x16_bf16 v[16:31], v[48:51], v[104:107], v[16:31]
    global_load_dwordx4 v[76:79], v12, s[36:37] offset:480
    ds_read_b128 v[104:107], v14 offset:400
    s_waitcnt vmcnt(6) lgkmcnt(3)
    v_mfma_f32_32x32x16_bf16 v[16:31], v[52:55], v[108:111], v[16:31]
    global_load_dwordx4 v[48:51], v12, s[36:37] offset:512
    ds_read_b128 v[108:111], v15 offset:400
    s_waitcnt vmcnt(6) lgkmcnt(3)
    v_mfma_f32_32x32x16_bf16 v[16:31], v[56:59], v[112:115], v[16:31]
    global_load_dwordx4 v[52:55], v12, s[36:37] offset:544
    ds_read_b128 v[112:115], v14 offset:384
    s_waitcnt vmcnt(6) lgkmcnt(3)
    v_mfma_f32_32x32x16_bf16 v[16:31], v[60:63], v[116:119], v[16:31]
    global_load_dwordx4 v[56:59], v12, s[36:37] offset:576
    ds_read_b128 v[116:119], v15 offset:384
    s_waitcnt vmcnt(6) lgkmcnt(3)
    v_mfma_f32_32x32x16_bf16 v[16:31], v[64:67], v[104:107], v[16:31]
    global_load_dwordx4 v[60:63], v12, s[36:37] offset:608
    ds_read_b128 v[104:107], v14 offset:368
    s_waitcnt vmcnt(6) lgkmcnt(3)
    v_mfma_f32_32x32x16_bf16 v[16:31], v[68:71], v[108:111], v[16:31]
    global_load_dwordx4 v[64:67], v12, s[36:37] offset:640
    ds_read_b128 v[108:111], v15 offset:368
    s_waitcnt vmcnt(6) lgkmcnt(3)
    v_mfma_f32_32x32x16_bf16 v[16:31], v[72:75], v[112:115], v[16:31]
    global_load_dwordx4 v[68:71], v12, s[36:37] offset:672
    ds_read_b128 v[112:115], v14 offset:352
    s_waitcnt vmcnt(6) lgkmcnt(3)
    v_mfma_f32_32x32x16_bf16 v[16:31], v[76:79], v[116:119], v[16:31]
    global_load_dwordx4 v[72:75], v12, s[36:37] offset:704
    ds_read_b128 v[116:119], v15 offset:352
    s_waitcnt vmcnt(6) lgkmcnt(3)
    v_mfma_f32_32x32x16_bf16 v[16:31], v[48:51], v[104:107], v[16:31]
    global_load_dwordx4 v[76:79], v12, s[36:37] offset:736
    ds_read_b128 v[104:107], v14 offset:336
    s_waitcnt vmcnt(6) lgkmcnt(3)
    v_mfma_f32_32x32x16_bf16 v[16:31], v[52:55], v[108:111], v[16:31]
    global_load_dwordx4 v[48:51], v12, s[36:37] offset:768
    ds_read_b128 v[108:111], v15 offset:336
    s_waitcnt vmcnt(6) lgkmcnt(3)
    v_mfma_f32_32x32x16_bf16 v[16:31], v[56:59], v[112:115], v[16:31]
    global_load_dwordx4 v[52:55], v12, s[36:37] offset:800
    ds_read_b128 v[112:115], v14 offset:320
    s_waitcnt vmcnt(6) lgkmcnt(3)
    v_mfma_f32_32x32x16_bf16 v[16:31], v[60:63], v[116:119], v[16:31]
    global_load_dwordx4 v[56:59], v12, s[36:37] offset:832
    ds_read_b128 v[116:119], v15 offset:320
    s_waitcnt vmcnt(6) lgkmcnt(3)
    v_mfma_f32_32x32x16_bf16 v[16:31], v[64:67], v[104:107], v[16:31]
    global_load_dwordx4 v[60:63], v12, s[36:37] offset:864
    ds_read_b128 v[104:107], v14 offset:304
    s_waitcnt vmcnt(6) lgkmcnt(3)
    v_mfma_f32_32x32x16_bf16 v[16:31], v[68:71], v[108:111], v[16:31]
    global_load_dwordx4 v[64:67], v12, s[36:37] offset:896
    ds_read_b128 v[108:111], v15 offset:304
    s_waitcnt vmcnt(6) lgkmcnt(3)
    v_mfma_f32_32x32x16_bf16 v[16:31], v[72:75], v[112:115], v[16:31]
    global_load_dwordx4 v[68:71], v12, s[36:37] offset:928
    ds_read_b128 v[112:115], v14 offset:288
    s_waitcnt vmcnt(6) lgkmcnt(3)
    v_mfma_f32_32x32x16_bf16 v[16:31], v[76:79], v[116:119], v[16:31]
    global_load_dwordx4 v[72:75], v12, s[36:37] offset:960
    ds_read_b128 v[116:119], v15 offset:288
    s_waitcnt vmcnt(6) lgkmcnt(3)
    v_mfma_f32_32x32x16_bf16 v[16:31], v[48:51], v[104:107], v[16:31]
    global_load_dwordx4 v[76:79], v12, s[36:37] offset:992
    ds_read_b128 v[104:107], v14 offset:272
    s_waitcnt vmcnt(6) lgkmcnt(3)
    v_mfma_f32_32x32x16_bf16 v[16:31], v[52:55], v[108:111], v[16:31]
    global_load_dwordx4 v[48:51], v12, s[36:37] offset:1024
    ds_read_b128 v[108:111], v15 offset:272
    s_waitcnt vmcnt(6) lgkmcnt(3)
    v_mfma_f32_32x32x16_bf16 v[16:31], v[56:59], v[112:115], v[16:31]
    global_load_dwordx4 v[52:55], v12, s[36:37] offset:1056
    ds_read_b128 v[112:115], v14 offset:256
    s_waitcnt vmcnt(6) lgkmcnt(3)
    v_mfma_f32_32x32x16_bf16 v[16:31], v[60:63], v[116:119], v[16:31]
    global_load_dwordx4 v[56:59], v12, s[36:37] offset:1088
    global_load_dwordx4 v[88:91], v12, s[36:37] offset:3072
    ds_read_b128 v[116:119], v15 offset:256
    s_waitcnt vmcnt(7) lgkmcnt(3)
    v_mfma_f32_32x32x16_bf16 v[16:31], v[64:67], v[104:107], v[16:31]
    global_load_dwordx4 v[60:63], v12, s[36:37] offset:1120
    global_load_dwordx4 v[92:95], v12, s[36:37] offset:3104
    ds_read_b128 v[104:107], v14 offset:240
    s_waitcnt vmcnt(8) lgkmcnt(3)
    v_mfma_f32_32x32x16_bf16 v[16:31], v[68:71], v[108:111], v[16:31]
    global_load_dwordx4 v[64:67], v12, s[36:37] offset:1152
    global_load_dwordx4 v[96:99], v12, s[36:37] offset:3136
    ds_read_b128 v[108:111], v15 offset:240
    s_waitcnt vmcnt(9) lgkmcnt(3)
    v_mfma_f32_32x32x16_bf16 v[16:31], v[72:75], v[112:115], v[16:31]
    global_load_dwordx4 v[68:71], v12, s[36:37] offset:1184
    global_load_dwordx4 v[100:103], v12, s[36:37] offset:3168
    ds_read_b128 v[112:115], v14 offset:224
    s_waitcnt vmcnt(10) lgkmcnt(3)
    v_mfma_f32_32x32x16_bf16 v[16:31], v[76:79], v[116:119], v[16:31]
    global_load_dwordx4 v[72:75], v12, s[36:37] offset:1216
    global_load_dwordx4 v[80:83], v12, s[36:37] offset:3200
    ds_read_b128 v[116:119], v15 offset:224
    s_waitcnt vmcnt(8) lgkmcnt(3)
    v_mfma_f32_32x32x16_bf16 v[16:31], v[48:51], v[104:107], v[16:31]
    v_mfma_f32_32x32x16_bf16 v[32:47], v[88:91], v[104:107], 0
    global_load_dwordx4 v[76:79], v12, s[36:37] offset:1248
    global_load_dwordx4 v[84:87], v12, s[36:37] offset:3232
    ds_read_b128 v[104:107], v14 offset:208
    s_waitcnt vmcnt(8) lgkmcnt(3)
    v_mfma_f32_32x32x16_bf16 v[16:31], v[52:55], v[108:111], v[16:31]
    v_mfma_f32_32x32x16_bf16 v[32:47], v[92:95], v[108:111], v[32:47]
    global_load_dwordx4 v[48:51], v12, s[36:37] offset:1280
    global_load_dwordx4 v[88:91], v12, s[36:37] offset:3264
    ds_read_b128 v[108:111], v15 offset:208
    s_waitcnt vmcnt(8) lgkmcnt(3)
    v_mfma_f32_32x32x16_bf16 v[16:31], v[56:59], v[112:115], v[16:31]
    v_mfma_f32_32x32x16_bf16 v[32:47], v[96:99], v[112:115], v[32:47]
    global_load_dwordx4 v[52:55], v12, s[36:37] offset:1312
    global_load_dwordx4 v[92:95], v12, s[36:37] offset:3296
    ds_read_b128 v[112:115], v14 offset:192
    s_waitcnt vmcnt(8) lgkmcnt(3)
    v_mfma_f32_32x32x16_bf16 v[16:31], v[60:63], v[116:119], v[16:31]
    v_mfma_f32_32x32x16_bf16 v[32:47], v[100:103], v[116:119], v[32:47]
    global_load_dwordx4 v[56:59], v12, s[36:37] offset:1344
    global_load_dwordx4 v[96:99], v12, s[36:37] offset:3328
    ds_read_b128 v[116:119], v15 offset:192
    s_waitcnt vmcnt(8) lgkmcnt(3)
    v_mfma_f32_32x32x16_bf16 v[16:31], v[64:67], v[104:107], v[16:31]
    v_mfma_f32_32x32x16_bf16 v[32:47], v[80:83], v[104:107], v[32:47]
    global_load_dwordx4 v[60:63], v12, s[36:37] offset:1376
    global_load_dwordx4 v[100:103], v12, s[36:37] offset:3360
    ds_read_b128 v[104:107], v14 offset:176
    s_waitcnt vmcnt(8) lgkmcnt(3)
    v_mfma_f32_32x32x16_bf16 v[16:31], v[68:71], v[108:111], v[16:31]
    v_mfma_f32_32x32x16_bf16 v[32:47], v[84:87], v[108:111], v[32:47]
    global_load_dwordx4 v[64:67], v12, s[36:37] offset:1408
    global_load_dwordx4 v[80:83], v12, s[36:37] offset:3392
    ds_read_b128 v[108:111], v15 offset:176
    s_waitcnt vmcnt(8) lgkmcnt(3)
    v_mfma_f32_32x32x16_bf16 v[16:31], v[72:75], v[112:115], v[16:31]
    v_mfma_f32_32x32x16_bf16 v[32:47], v[88:91], v[112:115], v[32:47]
    global_load_dwordx4 v[68:71], v12, s[36:37] offset:1440
    global_load_dwordx4 v[84:87], v12, s[36:37] offset:3424
    ds_read_b128 v[112:115], v14 offset:160
    s_waitcnt vmcnt(8) lgkmcnt(3)
    v_mfma_f32_32x32x16_bf16 v[16:31], v[76:79], v[116:119], v[16:31]
    v_mfma_f32_32x32x16_bf16 v[32:47], v[92:95], v[116:119], v[32:47]
    global_load_dwordx4 v[72:75], v12, s[36:37] offset:1472
    global_load_dwordx4 v[88:91], v12, s[36:37] offset:3456
    ds_read_b128 v[116:119], v15 offset:160
    s_waitcnt vmcnt(8) lgkmcnt(3)
    v_mfma_f32_32x32x16_bf16 v[16:31], v[48:51], v[104:107], v[16:31]
    v_mfma_f32_32x32x16_bf16 v[32:47], v[96:99], v[104:107], v[32:47]
    global_load_dwordx4 v[76:79], v12, s[36:37] offset:1504
    global_load_dwordx4 v[92:95], v12, s[36:37] offset:3488
    ds_read_b128 v[104:107], v14 offset:144
    s_waitcnt vmcnt(8) lgkmcnt(3)
    v_mfma_f32_32x32x16_bf16 v[16:31], v[52:55], v[108:111], v[16:31]
    v_mfma_f32_32x32x16_bf16 v[32:47], v[100:103], v[108:111], v[32:47]
    global_load_dwordx4 v[48:51], v12, s[36:37] offset:1536
    global_load_dwordx4 v[96:99], v12, s[36:37] offset:3520
    ds_read_b128 v[108:111], v15 offset:144
    s_waitcnt vmcnt(8) lgkmcnt(3)
    v_mfma_f32_32x32x16_bf16 v[16:31], v[56:59], v[112:115], v[16:31]
    v_mfma_f32_32x32x16_bf16 v[32:47], v[80:83], v[112:115], v[32:47]
    global_load_dwordx4 v[52:55], v12, s[36:37] offset:1568
    global_load_dwordx4 v[100:103], v12, s[36:37] offset:3552
    ds_read_b128 v[112:115], v14 offset:128
    s_waitcnt vmcnt(8) lgkmcnt(3)
    v_mfma_f32_32x32x16_bf16 v[16:31], v[60:63], v[116:119], v[16:31]
    v_mfma_f32_32x32x16_bf16 v[32:47], v[84:87], v[116:119], v[32:47]
    global_load_dwordx4 v[56:59], v12, s[36:37] offset:1600
    global_load_dwordx4 v[80:83], v12, s[36:37] offset:3584
    ds_read_b128 v[116:119], v15 offset:128
    s_waitcnt vmcnt(8) lgkmcnt(3)
    v_mfma_f32_32x32x16_bf16 v[16:31], v[64:67], v[104:107], v[16:31]
    v_mfma_f32_32x32x16_bf16 v[32:47], v[88:91], v[104:107], v[32:47]
    global_load_dwordx4 v[60:63], v12, s[36:37] offset:1632
    global_load_dwordx4 v[84:87], v12, s[36:37] offset:3616
    ds_read_b128 v[104:107], v14 offset:112
    s_waitcnt vmcnt(8) lgkmcnt(3)
    v_mfma_f32_32x32x16_bf16 v[16:31], v[68:71], v[108:111], v[16:31]
    v_mfma_f32_32x32x16_bf16 v[32:47], v[92:95], v[108:111], v[32:47]
    global_load_dwordx4 v[64:67], v12, s[36:37] offset:1664
    global_load_dwordx4 v[88:91], v12, s[36:37] offset:3648
    ds_read_b128 v[108:111], v15 offset:112
    s_waitcnt vmcnt(8) lgkmcnt(3)
    v_mfma_f32_32x32x16_bf16 v[16:31], v[72:75], v[112:115], v[16:31]
    v_mfma_f32_32x32x16_bf16 v[32:47], v[96:99], v[112:115], v[32:47]
    global_load_dwordx4 v[68:71], v12, s[36:37] offset:1696
    global_load_dwordx4 v[92:95], v12, s[36:37] offset:3680
    ds_read_b128 v[112:115], v14 offset:96
    s_waitcnt vmcnt(8) lgkmcnt(3)
    v_mfma_f32_32x32x16_bf16 v[16:31], v[76:79], v[116:119], v[16:31]
    v_mfma_f32_32x32x16_bf16 v[32:47], v[100:103], v[116:119], v[32:47]
    global_load_dwordx4 v[72:75], v12, s[36:37] offset:1728
    global_load_dwordx4 v[96:99], v12, s[36:37] offset:3712
    ds_read_b128 v[116:119], v15 offset:96
    s_waitcnt vmcnt(8) lgkmcnt(3)
    v_mfma_f32_32x32x16_bf16 v[16:31], v[48:51], v[104:107], v[16:31]
    v_mfma_f32_32x32x16_bf16 v[32:47], v[80:83], v[104:107], v[32:47]
    global_load_dwordx4 v[76:79], v12, s[36:37] offset:1760
    global_load_dwordx4 v[100:103], v12, s[36:37] offset:3744
    ds_read_b128 v[104:107], v14 offset:80
    s_waitcnt vmcnt(8) lgkmcnt(3)
    v_mfma_f32_32x32x16_bf16 v[16:31], v[52:55], v[108:111], v[16:31]
    v_mfma_f32_32x32x16_bf16 v[32:47], v[84:87], v[108:111], v[32:47]
    global_load_dwordx4 v[48:51], v12, s[36:37] offset:1792
    global_load_dwordx4 v[80:83], v12, s[36:37] offset:3776
    ds_read_b128 v[108:111], v15 offset:80
    s_waitcnt vmcnt(8) lgkmcnt(3)
    v_mfma_f32_32x32x16_bf16 v[16:31], v[56:59], v[112:115], v[16:31]
    v_mfma_f32_32x32x16_bf16 v[32:47], v[88:91], v[112:115], v[32:47]
    global_load_dwordx4 v[52:55], v12, s[36:37] offset:1824
    global_load_dwordx4 v[84:87], v12, s[36:37] offset:3808
    ds_read_b128 v[112:115], v14 offset:64
    s_waitcnt vmcnt(8) lgkmcnt(3)
    v_mfma_f32_32x32x16_bf16 v[16:31], v[60:63], v[116:119], v[16:31]
    v_mfma_f32_32x32x16_bf16 v[32:47], v[92:95], v[116:119], v[32:47]
    global_load_dwordx4 v[56:59], v12, s[36:37] offset:1856
    global_load_dwordx4 v[88:91], v12, s[36:37] offset:3840
    ds_read_b128 v[116:119], v15 offset:64
    s_waitcnt vmcnt(8) lgkmcnt(3)
    v_mfma_f32_32x32x16_bf16 v[16:31], v[64:67], v[104:107], v[16:31]
    v_mfma_f32_32x32x16_bf16 v[32:47], v[96:99], v[104:107], v[32:47]
    global_load_dwordx4 v[60:63], v12, s[36:37] offset:1888
    global_load_dwordx4 v[92:95], v12, s[36:37] offset:3872
    ds_read_b128 v[104:107], v14 offset:48
    s_waitcnt vmcnt(8) lgkmcnt(3)
    v_mfma_f32_32x32x16_bf16 v[16:31], v[68:71], v[108:111], v[16:31]
    v_mfma_f32_32x32x16_bf16 v[32:47], v[100:103], v[108:111], v[32:47]
    global_load_dwordx4 v[64:67], v12, s[36:37] offset:1920
    global_load_dwordx4 v[96:99], v12, s[36:37] offset:3904
    ds_read_b128 v[108:111], v15 offset:48
    s_waitcnt vmcnt(8) lgkmcnt(3)
    v_mfma_f32_32x32x16_bf16 v[16:31], v[72:75], v[112:115], v[16:31]
    v_mfma_f32_32x32x16_bf16 v[32:47], v[80:83], v[112:115], v[32:47]
    global_load_dwordx4 v[68:71], v12, s[36:37] offset:1952
    global_load_dwordx4 v[100:103], v12, s[36:37] offset:3936
    ds_read_b128 v[112:115], v14 offset:32
    s_waitcnt vmcnt(8) lgkmcnt(3)
    v_mfma_f32_32x32x16_bf16 v[16:31], v[76:79], v[116:119], v[16:31]
    v_mfma_f32_32x32x16_bf16 v[32:47], v[84:87], v[116:119], v[32:47]
    global_load_dwordx4 v[72:75], v12, s[36:37] offset:1984
    global_load_dwordx4 v[80:83], v12, s[36:37] offset:3968
    ds_read_b128 v[116:119], v15 offset:32
    s_waitcnt vmcnt(8) lgkmcnt(3)
    v_mfma_f32_32x32x16_bf16 v[16:31], v[48:51], v[104:107], v[16:31]
    v_mfma_f32_32x32x16_bf16 v[32:47], v[88:91], v[104:107], v[32:47]
    global_load_dwordx4 v[76:79], v12, s[36:37] offset:2016
    global_load_dwordx4 v[84:87], v12, s[36:37] offset:4000
    ds_read_b128 v[104:107], v14 offset:16
    s_waitcnt vmcnt(8) lgkmcnt(3)
    v_mfma_f32_32x32x16_bf16 v[16:31], v[52:55], v[108:111], v[16:31]
    v_mfma_f32_32x32x16_bf16 v[32:47], v[92:95], v[108:111], v[32:47]
    global_load_dwordx4 v[88:91], v12, s[36:37] offset:4032
    ds_read_b128 v[108:111], v15 offset:16
    s_waitcnt vmcnt(7) lgkmcnt(3)
    v_mfma_f32_32x32x16_bf16 v[16:31], v[56:59], v[112:115], v[16:31]
    v_mfma_f32_32x32x16_bf16 v[32:47], v[96:99], v[112:115], v[32:47]
    global_load_dwordx4 v[92:95], v12, s[36:37] offset:4064
    ds_read_b128 v[112:115], v14 offset:0
    s_waitcnt vmcnt(6) lgkmcnt(3)
    v_mfma_f32_32x32x16_bf16 v[16:31], v[60:63], v[116:119], v[16:31]
    v_mfma_f32_32x32x16_bf16 v[32:47], v[100:103], v[116:119], v[32:47]
    ds_read_b128 v[116:119], v15 offset:0
    s_waitcnt vmcnt(4) lgkmcnt(3)
    v_mfma_f32_32x32x16_bf16 v[16:31], v[64:67], v[104:107], v[16:31]
    v_mfma_f32_32x32x16_bf16 v[32:47], v[80:83], v[104:107], v[32:47]
    s_waitcnt vmcnt(2) lgkmcnt(2)
    v_mfma_f32_32x32x16_bf16 v[16:31], v[68:71], v[108:111], v[16:31]
    v_mfma_f32_32x32x16_bf16 v[32:47], v[84:87], v[108:111], v[32:47]
    s_waitcnt vmcnt(1) lgkmcnt(1)
    v_mfma_f32_32x32x16_bf16 v[16:31], v[72:75], v[112:115], v[16:31]
    v_mfma_f32_32x32x16_bf16 v[32:47], v[88:91], v[112:115], v[32:47]
    s_waitcnt vmcnt(0) lgkmcnt(0)
    v_mfma_f32_32x32x16_bf16 v[16:31], v[76:79], v[116:119], v[16:31]
    v_mfma_f32_32x32x16_bf16 v[32:47], v[92:95], v[116:119], v[32:47]
    s_setprio 3
    s_lshl_b32 s40, s28, 12
    s_add_u32 s40, s40, 143360
    v_add_u32 v6, s40, v3
    s_lshl_b32 s41, s28, 2
    s_add_u32 s41, s41, 161832
    v_mov_b32 v9, s41
    v_mul_u32_u24 v7, 1536, v5
    v_lshl_add_u32 v7, v4, 4, v7
    v_add_u32 v7, s33, v7
    ds_read_b128 v[64:67], v7 offset:512
    ds_read_b128 v[68:71], v7 offset:3584
    v_lshlrev_b32 v8, 10, v5
    v_lshl_add_u32 v8, v4, 4, v8
    s_lshl_b32 s43, s30, 12
    s_add_u32 s43, s43, 15728640
    v_add_u32 v8, s43, v8
    s_nop 5
    ds_write_b128 v6, v[32:35] offset:0
    ds_write_b128 v6, v[36:39] offset:1024
    ds_write_b128 v6, v[40:43] offset:2048
    ds_write_b128 v6, v[44:47] offset:3072
    s_waitcnt lgkmcnt(0)
    v_mov_b32 v10, 1
    s_mov_b64 exec, 1
    ds_write_b32 v9, v10
    s_mov_b64 exec, -1
    s_waitcnt lgkmcnt(0)
    v_and_b32 v80, 0xffff0000, v67
    v_lshlrev_b32 v81, 16, v67
    v_fma_f32 v80, v80, v13, v16
    v_fma_f32 v81, v81, v13, v24
    v_cvt_pk_bf16_f32 v88, v80, v81
    v_and_b32 v82, 0xffff0000, v66
    v_lshlrev_b32 v83, 16, v66
    v_fma_f32 v82, v82, v13, v17
    v_fma_f32 v83, v83, v13, v25
    v_cvt_pk_bf16_f32 v89, v82, v83
    v_and_b32 v80, 0xffff0000, v65
    v_lshlrev_b32 v81, 16, v65
    v_fma_f32 v80, v80, v13, v18
    v_fma_f32 v81, v81, v13, v26
    v_cvt_pk_bf16_f32 v90, v80, v81
    v_and_b32 v82, 0xffff0000, v64
    v_lshlrev_b32 v83, 16, v64
    v_fma_f32 v82, v82, v13, v19
    v_fma_f32 v83, v83, v13, v27
    v_cvt_pk_bf16_f32 v91, v82, v83
    global_store_dwordx4 v8, v[88:91], s[62:63] offset:0 sc1
    v_and_b32 v80, 0xffff0000, v71
    v_lshlrev_b32 v81, 16, v71
    v_fma_f32 v80, v80, v13, v20
    v_fma_f32 v81, v81, v13, v28
    v_cvt_pk_bf16_f32 v92, v80, v81
    v_and_b32 v82, 0xffff0000, v70
    v_lshlrev_b32 v83, 16, v70
    v_fma_f32 v82, v82, v13, v21
    v_fma_f32 v83, v83, v13, v29
    v_cvt_pk_bf16_f32 v93, v82, v83
    v_and_b32 v80, 0xffff0000, v69
    v_lshlrev_b32 v81, 16, v69
    v_fma_f32 v80, v80, v13, v22
    v_fma_f32 v81, v81, v13, v30
    v_cvt_pk_bf16_f32 v94, v80, v81
    v_and_b32 v82, 0xffff0000, v68
    v_lshlrev_b32 v83, 16, v68
    v_fma_f32 v82, v82, v13, v23
    v_fma_f32 v83, v83, v13, v31
    v_cvt_pk_bf16_f32 v95, v82, v83
    global_store_dwordx4 v8, v[92:95], s[62:63] offset:2048 sc1
    s_branch CV_DONE
CV_Y:
    v_sub_u32 v7, 3, v5
    v_mul_u32_u24 v14, 1536, v7
    v_lshl_add_u32 v14, v4, 4, v14
    v_add_u32 v14, s33, v14
    v_add_u32 v14, 272, v14
    v_subrev_u32 v15, 3072, v14
    global_load_dwordx4 v[48:51], v12, s[36:37] offset:0
    global_load_dwordx4 v[52:55], v12, s[36:37] offset:32
    global_load_dwordx4 v[56:59], v12, s[36:37] offset:64
    global_load_dwordx4 v[60:63], v12, s[36:37] offset:96
    global_load_dwordx4 v[64:67], v12, s[36:37] offset:128
    global_load_dwordx4 v[68:71], v12, s[36:37] offset:160
    ds_read_b128 v[104:107], v14 offset:752
    ds_read_b128 v[108:111], v15 offset:752
    ds_read_b128 v[112:115], v14 offset:736
    global_load_dwordx4 v[72:75], v12, s[36:37] offset:192
    ds_read_b128 v[116:119], v15 offset:736
    s_waitcnt vmcnt(6) lgkmcnt(3)
    v_mfma_f32_32x32x16_bf16 v[32:47], v[48:51], v[104:107], 0
    global_load_dwordx4 v[76:79], v12, s[36:37] offset:224
    ds_read_b128 v[104:107], v14 offset:720
    s_waitcnt vmcnt(6) lgkmcnt(3)
    v_mfma_f32_32x32x16_bf16 v[32:47], v[52:55], v[108:111], v[32:47]
    global_load_dwordx4 v[48:51], v12, s[36:37] offset:256
    ds_read_b128 v[108:111], v15 offset:720
    s_waitcnt vmcnt(6) lgkmcnt(3)
    v_mfma_f32_32x32x16_bf16 v[32:47], v[56:59], v[112:115], v[32:47]
    global_load_dwordx4 v[52:55], v12, s[36:37] offset:288
    ds_read_b128 v[112:115], v14 offset:704
    s_waitcnt vmcnt(6) lgkmcnt(3)
    v_mfma_f32_32x32x16_bf16 v[32:47], v[60:63], v[116:119], v[32:47]
    global_load_dwordx4 v[56:59], v12, s[36:37] offset:320
    ds_read_b128 v[116:119], v15 offset:704
    s_waitcnt vmcnt(6) lgkmcnt(3)
    v_mfma_f32_32x32x16_bf16 v[32:47], v[64:67], v[104:107], v[32:47]
    global_load_dwordx4 v[60:63], v12, s[36:37] offset:352
    ds_read_b128 v[104:107], v14 offset:688
    s_waitcnt vmcnt(6) lgkmcnt(3)
    v_mfma_f32_32x32x16_bf16 v[32:47], v[68:71], v[108:111], v[32:47]
    global_load_dwordx4 v[64:67], v12, s[36:37] offset:384
    ds_read_b128 v[108:111], v15 offset:688
    s_waitcnt vmcnt(6) lgkmcnt(3)
    v_mfma_f32_32x32x16_bf16 v[32:47], v[72:75], v[112:115], v[32:47]
    global_load_dwordx4 v[68:71], v12, s[36:37] offset:416
    ds_read_b128 v[112:115], v14 offset:672
    s_waitcnt vmcnt(6) lgkmcnt(3)
    v_mfma_f32_32x32x16_bf16 v[32:47], v[76:79], v[116:119], v[32:47]
    global_load_dwordx4 v[72:75], v12, s[36:37] offset:448
    ds_read_b128 v[116:119], v15 offset:672
    s_waitcnt vmcnt(6) lgkmcnt(3)
    v_mfma_f32_32x32x16_bf16 v[32:47], v[48:51], v[104:107], v[32:47]
    global_load_dwordx4 v[76:79], v12, s[36:37] offset:480
    ds_read_b128 v[104:107], v14 offset:656
    s_waitcnt vmcnt(6) lgkmcnt(3)
    v_mfma_f32_32x32x16_bf16 v[32:47], v[52:55], v[108:111], v[32:47]
    global_load_dwordx4 v[48:51], v12, s[36:37] offset:512
    ds_read_b128 v[108:111], v15 offset:656
    s_waitcnt vmcnt(6) lgkmcnt(3)
    v_mfma_f32_32x32x16_bf16 v[32:47], v[56:59], v[112:115], v[32:47]
    global_load_dwordx4 v[52:55], v12, s[36:37] offset:544
    ds_read_b128 v[112:115], v14 offset:640
    s_waitcnt vmcnt(6) lgkmcnt(3)
    v_mfma_f32_32x32x16_bf16 v[32:47], v[60:63], v[116:119], v[32:47]
    global_load_dwordx4 v[56:59], v12, s[36:37] offset:576
    ds_read_b128 v[116:119], v15 offset:640
    s_waitcnt vmcnt(6) lgkmcnt(3)
    v_mfma_f32_32x32x16_bf16 v[32:47], v[64:67], v[104:107], v[32:47]
    global_load_dwordx4 v[60:63], v12, s[36:37] offset:608
    ds_read_b128 v[104:107], v14 offset:624
    s_waitcnt vmcnt(6) lgkmcnt(3)
    v_mfma_f32_32x32x16_bf16 v[32:47], v[68:71], v[108:111], v[32:47]
    global_load_dwordx4 v[64:67], v12, s[36:37] offset:640
    ds_read_b128 v[108:111], v15 offset:624
    s_waitcnt vmcnt(6) lgkmcnt(3)
    v_mfma_f32_32x32x16_bf16 v[32:47], v[72:75], v[112:115], v[32:47]
    global_load_dwordx4 v[68:71], v12, s[36:37] offset:672
    ds_read_b128 v[112:115], v14 offset:608
    s_waitcnt vmcnt(6) lgkmcnt(3)
    v_mfma_f32_32x32x16_bf16 v[32:47], v[76:79], v[116:119], v[32:47]
    global_load_dwordx4 v[72:75], v12, s[36:37] offset:704
    ds_read_b128 v[116:119], v15 offset:608
    s_waitcnt vmcnt(6) lgkmcnt(3)
    v_mfma_f32_32x32x16_bf16 v[32:47], v[48:51], v[104:107], v[32:47]
    global_load_dwordx4 v[76:79], v12, s[36:37] offset:736
    ds_read_b128 v[104:107], v14 offset:592
    s_waitcnt vmcnt(6) lgkmcnt(3)
    v_mfma_f32_32x32x16_bf16 v[32:47], v[52:55], v[108:111], v[32:47]
    global_load_dwordx4 v[48:51], v12, s[36:37] offset:768
    ds_read_b128 v[108:111], v15 offset:592
    s_waitcnt vmcnt(6) lgkmcnt(3)
    v_mfma_f32_32x32x16_bf16 v[32:47], v[56:59], v[112:115], v[32:47]
    global_load_dwordx4 v[52:55], v12, s[36:37] offset:800
    ds_read_b128 v[112:115], v14 offset:576
    s_waitcnt vmcnt(6) lgkmcnt(3)
    v_mfma_f32_32x32x16_bf16 v[32:47], v[60:63], v[116:119], v[32:47]
    global_load_dwordx4 v[56:59], v12, s[36:37] offset:832
    ds_read_b128 v[116:119], v15 offset:576
    s_waitcnt vmcnt(6) lgkmcnt(3)
    v_mfma_f32_32x32x16_bf16 v[32:47], v[64:67], v[104:107], v[32:47]
    global_load_dwordx4 v[60:63], v12, s[36:37] offset:864
    ds_read_b128 v[104:107], v14 offset:560
    s_waitcnt vmcnt(6) lgkmcnt(3)
    v_mfma_f32_32x32x16_bf16 v[32:47], v[68:71], v[108:111], v[32:47]
    global_load_dwordx4 v[64:67], v12, s[36:37] offset:896
    ds_read_b128 v[108:111], v15 offset:560
    s_waitcnt vmcnt(6) lgkmcnt(3)
    v_mfma_f32_32x32x16_bf16 v[32:47], v[72:75], v[112:115], v[32:47]
    global_load_dwordx4 v[68:71], v12, s[36:37] offset:928
    ds_read_b128 v[112:115], v14 offset:544
    s_waitcnt vmcnt(6) lgkmcnt(3)
    v_mfma_f32_32x32x16_bf16 v[32:47], v[76:79], v[116:119], v[32:47]
    global_load_dwordx4 v[72:75], v12, s[36:37] offset:960
    ds_read_b128 v[116:119], v15 offset:544
    s_waitcnt vmcnt(6) lgkmcnt(3)
    v_mfma_f32_32x32x16_bf16 v[32:47], v[48:51], v[104:107], v[32:47]
    global_load_dwordx4 v[76:79], v12, s[36:37] offset:992
    ds_read_b128 v[104:107], v14 offset:528
    s_waitcnt vmcnt(6) lgkmcnt(3)
    v_mfma_f32_32x32x16_bf16 v[32:47], v[52:55], v[108:111], v[32:47]
    global_load_dwordx4 v[48:51], v12, s[36:37] offset:1024
    ds_read_b128 v[108:111], v15 offset:528
    s_waitcnt vmcnt(6) lgkmcnt(3)
    v_mfma_f32_32x32x16_bf16 v[32:47], v[56:59], v[112:115], v[32:47]
    global_load_dwordx4 v[52:55], v12, s[36:37] offset:1056
    ds_read_b128 v[112:115], v14 offset:512
    s_waitcnt vmcnt(6) lgkmcnt(3)
    v_mfma_f32_32x32x16_bf16 v[32:47], v[60:63], v[116:119], v[32:47]
    global_load_dwordx4 v[56:59], v12, s[36:37] offset:1088
    ds_read_b128 v[116:119], v15 offset:512
    s_waitcnt vmcnt(6) lgkmcnt(3)
    v_mfma_f32_32x32x16_bf16 v[32:47], v[64:67], v[104:107], v[32:47]
    global_load_dwordx4 v[60:63], v12, s[36:37] offset:1120
    ds_read_b128 v[104:107], v14 offset:496
    s_waitcnt vmcnt(6) lgkmcnt(3)
    v_mfma_f32_32x32x16_bf16 v[32:47], v[68:71], v[108:111], v[32:47]
    global_load_dwordx4 v[64:67], v12, s[36:37] offset:1152
    ds_read_b128 v[108:111], v15 offset:496
    s_waitcnt vmcnt(6) lgkmcnt(3)
    v_mfma_f32_32x32x16_bf16 v[32:47], v[72:75], v[112:115], v[32:47]
    global_load_dwordx4 v[68:71], v12, s[36:37] offset:1184
    ds_read_b128 v[112:115], v14 offset:480
    s_waitcnt vmcnt(6) lgkmcnt(3)
    v_mfma_f32_32x32x16_bf16 v[32:47], v[76:79], v[116:119], v[32:47]
    global_load_dwordx4 v[72:75], v12, s[36:37] offset:1216
    ds_read_b128 v[116:119], v15 offset:480
    s_waitcnt vmcnt(6) lgkmcnt(3)
    v_mfma_f32_32x32x16_bf16 v[32:47], v[48:51], v[104:107], v[32:47]
    global_load_dwordx4 v[76:79], v12, s[36:37] offset:1248
    ds_read_b128 v[104:107], v14 offset:464
    s_waitcnt vmcnt(6) lgkmcnt(3)
    v_mfma_f32_32x32x16_bf16 v[32:47], v[52:55], v[108:111], v[32:47]
    global_load_dwordx4 v[48:51], v12, s[36:37] offset:1280
    ds_read_b128 v[108:111], v15 offset:464
    s_waitcnt vmcnt(6) lgkmcnt(3)
    v_mfma_f32_32x32x16_bf16 v[32:47], v[56:59], v[112:115], v[32:47]
    global_load_dwordx4 v[52:55], v12, s[36:37] offset:1312
    ds_read_b128 v[112:115], v14 offset:448
    s_waitcnt vmcnt(6) lgkmcnt(3)
    v_mfma_f32_32x32x16_bf16 v[32:47], v[60:63], v[116:119], v[32:47]
    global_load_dwordx4 v[56:59], v12, s[36:37] offset:1344
    ds_read_b128 v[116:119], v15 offset:448
    s_waitcnt vmcnt(6) lgkmcnt(3)
    v_mfma_f32_32x32x16_bf16 v[32:47], v[64:67], v[104:107], v[32:47]
    global_load_dwordx4 v[60:63], v12, s[36:37] offset:1376
    ds_read_b128 v[104:107], v14 offset:432
    s_waitcnt vmcnt(6) lgkmcnt(3)
    v_mfma_f32_32x32x16_bf16 v[32:47], v[68:71], v[108:111], v[32:47]
    global_load_dwordx4 v[64:67], v12, s[36:37] offset:1408
    ds_read_b128 v[108:111], v15 offset:432
    s_waitcnt vmcnt(6) lgkmcnt(3)
    v_mfma_f32_32x32x16_bf16 v[32:47], v[72:75], v[112:115], v[32:47]
    global_load_dwordx4 v[68:71], v12, s[36:37] offset:1440
    ds_read_b128 v[112:115], v14 offset:416
    s_waitcnt vmcnt(6) lgkmcnt(3)
    v_mfma_f32_32x32x16_bf16 v[32:47], v[76:79], v[116:119], v[32:47]
    global_load_dwordx4 v[72:75], v12, s[36:37] offset:1472
    ds_read_b128 v[116:119], v15 offset:416
    s_waitcnt vmcnt(6) lgkmcnt(3)
    v_mfma_f32_32x32x16_bf16 v[32:47], v[48:51], v[104:107], v[32:47]
    global_load_dwordx4 v[76:79], v12, s[36:37] offset:1504
    ds_read_b128 v[104:107], v14 offset:400
    s_waitcnt vmcnt(6) lgkmcnt(3)
    v_mfma_f32_32x32x16_bf16 v[32:47], v[52:55], v[108:111], v[32:47]
    global_load_dwordx4 v[48:51], v12, s[36:37] offset:1536
    ds_read_b128 v[108:111], v15 offset:400
    s_waitcnt vmcnt(6) lgkmcnt(3)
    v_mfma_f32_32x32x16_bf16 v[32:47], v[56:59], v[112:115], v[32:47]
    global_load_dwordx4 v[52:55], v12, s[36:37] offset:1568
    ds_read_b128 v[112:115], v14 offset:384
    s_waitcnt vmcnt(6) lgkmcnt(3)
    v_mfma_f32_32x32x16_bf16 v[32:47], v[60:63], v[116:119], v[32:47]
    global_load_dwordx4 v[56:59], v12, s[36:37] offset:1600
    ds_read_b128 v[116:119], v15 offset:384
    s_waitcnt vmcnt(6) lgkmcnt(3)
    v_mfma_f32_32x32x16_bf16 v[32:47], v[64:67], v[104:107], v[32:47]
    global_load_dwordx4 v[60:63], v12, s[36:37] offset:1632
    ds_read_b128 v[104:107], v14 offset:368
    s_waitcnt vmcnt(6) lgkmcnt(3)
    v_mfma_f32_32x32x16_bf16 v[32:47], v[68:71], v[108:111], v[32:47]
    global_load_dwordx4 v[64:67], v12, s[36:37] offset:1664
    ds_read_b128 v[108:111], v15 offset:368
    s_waitcnt vmcnt(6) lgkmcnt(3)
    v_mfma_f32_32x32x16_bf16 v[32:47], v[72:75], v[112:115], v[32:47]
    global_load_dwordx4 v[68:71], v12, s[36:37] offset:1696
    ds_read_b128 v[112:115], v14 offset:352
    s_waitcnt vmcnt(6) lgkmcnt(3)
    v_mfma_f32_32x32x16_bf16 v[32:47], v[76:79], v[116:119], v[32:47]
    global_load_dwordx4 v[72:75], v12, s[36:37] offset:1728
    ds_read_b128 v[116:119], v15 offset:352
    s_waitcnt vmcnt(6) lgkmcnt(3)
    v_mfma_f32_32x32x16_bf16 v[32:47], v[48:51], v[104:107], v[32:47]
    global_load_dwordx4 v[76:79], v12, s[36:37] offset:1760
    ds_read_b128 v[104:107], v14 offset:336
    s_waitcnt vmcnt(6) lgkmcnt(3)
    v_mfma_f32_32x32x16_bf16 v[32:47], v[52:55], v[108:111], v[32:47]
    global_load_dwordx4 v[48:51], v12, s[36:37] offset:1792
    ds_read_b128 v[108:111], v15 offset:336
    s_waitcnt vmcnt(6) lgkmcnt(3)
    v_mfma_f32_32x32x16_bf16 v[32:47], v[56:59], v[112:115], v[32:47]
    global_load_dwordx4 v[52:55], v12, s[36:37] offset:1824
    ds_read_b128 v[112:115], v14 offset:320
    s_waitcnt vmcnt(6) lgkmcnt(3)
    v_mfma_f32_32x32x16_bf16 v[32:47], v[60:63], v[116:119], v[32:47]
    global_load_dwordx4 v[56:59], v12, s[36:37] offset:1856
    ds_read_b128 v[116:119], v15 offset:320
    s_waitcnt vmcnt(6) lgkmcnt(3)
    v_mfma_f32_32x32x16_bf16 v[32:47], v[64:67], v[104:107], v[32:47]
    global_load_dwordx4 v[60:63], v12, s[36:37] offset:1888
    ds_read_b128 v[104:107], v14 offset:304
    s_waitcnt vmcnt(6) lgkmcnt(3)
    v_mfma_f32_32x32x16_bf16 v[32:47], v[68:71], v[108:111], v[32:47]
    global_load_dwordx4 v[64:67], v12, s[36:37] offset:1920
    ds_read_b128 v[108:111], v15 offset:304
    s_waitcnt vmcnt(6) lgkmcnt(3)
    v_mfma_f32_32x32x16_bf16 v[32:47], v[72:75], v[112:115], v[32:47]
    global_load_dwordx4 v[68:71], v12, s[36:37] offset:1952
    ds_read_b128 v[112:115], v14 offset:288
    s_waitcnt vmcnt(6) lgkmcnt(3)
    v_mfma_f32_32x32x16_bf16 v[32:47], v[76:79], v[116:119], v[32:47]
    global_load_dwordx4 v[72:75], v12, s[36:37] offset:1984
    ds_read_b128 v[116:119], v15 offset:288
    s_waitcnt vmcnt(6) lgkmcnt(3)
    v_mfma_f32_32x32x16_bf16 v[32:47], v[48:51], v[104:107], v[32:47]
    global_load_dwordx4 v[76:79], v12, s[36:37] offset:2016
    ds_read_b128 v[104:107], v14 offset:272
    s_waitcnt vmcnt(6) lgkmcnt(3)
    v_mfma_f32_32x32x16_bf16 v[32:47], v[52:55], v[108:111], v[32:47]
    global_load_dwordx4 v[48:51], v12, s[36:37] offset:2048
    ds_read_b128 v[108:111], v15 offset:272
    s_waitcnt vmcnt(6) lgkmcnt(3)
    v_mfma_f32_32x32x16_bf16 v[32:47], v[56:59], v[112:115], v[32:47]
    global_load_dwordx4 v[52:55], v12, s[36:37] offset:2080
    ds_read_b128 v[112:115], v14 offset:256
    s_waitcnt vmcnt(6) lgkmcnt(3)
    v_mfma_f32_32x32x16_bf16 v[32:47], v[60:63], v[116:119], v[32:47]
    global_load_dwordx4 v[56:59], v12, s[36:37] offset:2112
    ds_read_b128 v[116:119], v15 offset:256
    s_waitcnt vmcnt(6) lgkmcnt(3)
    v_mfma_f32_32x32x16_bf16 v[32:47], v[64:67], v[104:107], v[32:47]
    global_load_dwordx4 v[60:63], v12, s[36:37] offset:2144
    ds_read_b128 v[104:107], v14 offset:240
    s_waitcnt vmcnt(6) lgkmcnt(3)
    v_mfma_f32_32x32x16_bf16 v[32:47], v[68:71], v[108:111], v[32:47]
    global_load_dwordx4 v[64:67], v12, s[36:37] offset:2176
    ds_read_b128 v[108:111], v15 offset:240
    s_waitcnt vmcnt(6) lgkmcnt(3)
    v_mfma_f32_32x32x16_bf16 v[32:47], v[72:75], v[112:115], v[32:47]
    global_load_dwordx4 v[68:71], v12, s[36:37] offset:2208
    ds_read_b128 v[112:115], v14 offset:224
    s_waitcnt vmcnt(6) lgkmcnt(3)
    v_mfma_f32_32x32x16_bf16 v[32:47], v[76:79], v[116:119], v[32:47]
    global_load_dwordx4 v[72:75], v12, s[36:37] offset:2240
    ds_read_b128 v[116:119], v15 offset:224
    s_waitcnt vmcnt(6) lgkmcnt(3)
    v_mfma_f32_32x32x16_bf16 v[32:47], v[48:51], v[104:107], v[32:47]
    global_load_dwordx4 v[76:79], v12, s[36:37] offset:2272
    ds_read_b128 v[104:107], v14 offset:208
    s_waitcnt vmcnt(6) lgkmcnt(3)
    v_mfma_f32_32x32x16_bf16 v[32:47], v[52:55], v[108:111], v[32:47]
    global_load_dwordx4 v[48:51], v12, s[36:37] offset:2304
    ds_read_b128 v[108:111], v15 offset:208
    s_waitcnt vmcnt(6) lgkmcnt(3)
    v_mfma_f32_32x32x16_bf16 v[32:47], v[56:59], v[112:115], v[32:47]
    global_load_dwordx4 v[52:55], v12, s[36:37] offset:2336
    ds_read_b128 v[112:115], v14 offset:192
    s_waitcnt vmcnt(6) lgkmcnt(3)
    v_mfma_f32_32x32x16_bf16 v[32:47], v[60:63], v[116:119], v[32:47]
    global_load_dwordx4 v[56:59], v12, s[36:37] offset:2368
    ds_read_b128 v[116:119], v15 offset:192
    s_waitcnt vmcnt(6) lgkmcnt(3)
    v_mfma_f32_32x32x16_bf16 v[32:47], v[64:67], v[104:107], v[32:47]
    global_load_dwordx4 v[60:63], v12, s[36:37] offset:2400
    ds_read_b128 v[104:107], v14 offset:176
    s_waitcnt vmcnt(6) lgkmcnt(3)
    v_mfma_f32_32x32x16_bf16 v[32:47], v[68:71], v[108:111], v[32:47]
    global_load_dwordx4 v[64:67], v12, s[36:37] offset:2432
    ds_read_b128 v[108:111], v15 offset:176
    s_waitcnt vmcnt(6) lgkmcnt(3)
    v_mfma_f32_32x32x16_bf16 v[32:47], v[72:75], v[112:115], v[32:47]
    global_load_dwordx4 v[68:71], v12, s[36:37] offset:2464
    ds_read_b128 v[112:115], v14 offset:160
    s_waitcnt vmcnt(6) lgkmcnt(3)
    v_mfma_f32_32x32x16_bf16 v[32:47], v[76:79], v[116:119], v[32:47]
    global_load_dwordx4 v[72:75], v12, s[36:37] offset:2496
    ds_read_b128 v[116:119], v15 offset:160
    s_waitcnt vmcnt(6) lgkmcnt(3)
    v_mfma_f32_32x32x16_bf16 v[32:47], v[48:51], v[104:107], v[32:47]
    global_load_dwordx4 v[76:79], v12, s[36:37] offset:2528
    ds_read_b128 v[104:107], v14 offset:144
    s_waitcnt vmcnt(6) lgkmcnt(3)
    v_mfma_f32_32x32x16_bf16 v[32:47], v[52:55], v[108:111], v[32:47]
    global_load_dwordx4 v[48:51], v12, s[36:37] offset:2560
    ds_read_b128 v[108:111], v15 offset:144
    s_waitcnt vmcnt(6) lgkmcnt(3)
    v_mfma_f32_32x32x16_bf16 v[32:47], v[56:59], v[112:115], v[32:47]
    global_load_dwordx4 v[52:55], v12, s[36:37] offset:2592
    ds_read_b128 v[112:115], v14 offset:128
    s_waitcnt vmcnt(6) lgkmcnt(3)
    v_mfma_f32_32x32x16_bf16 v[32:47], v[60:63], v[116:119], v[32:47]
    global_load_dwordx4 v[56:59], v12, s[36:37] offset:2624
    ds_read_b128 v[116:119], v15 offset:128
    s_waitcnt vmcnt(6) lgkmcnt(3)
    v_mfma_f32_32x32x16_bf16 v[32:47], v[64:67], v[104:107], v[32:47]
    global_load_dwordx4 v[60:63], v12, s[36:37] offset:2656
    ds_read_b128 v[104:107], v14 offset:112
    s_waitcnt vmcnt(6) lgkmcnt(3)
    v_mfma_f32_32x32x16_bf16 v[32:47], v[68:71], v[108:111], v[32:47]
    global_load_dwordx4 v[64:67], v12, s[36:37] offset:2688
    ds_read_b128 v[108:111], v15 offset:112
    s_waitcnt vmcnt(6) lgkmcnt(3)
    v_mfma_f32_32x32x16_bf16 v[32:47], v[72:75], v[112:115], v[32:47]
    global_load_dwordx4 v[68:71], v12, s[36:37] offset:2720
    ds_read_b128 v[112:115], v14 offset:96
    s_waitcnt vmcnt(6) lgkmcnt(3)
    v_mfma_f32_32x32x16_bf16 v[32:47], v[76:79], v[116:119], v[32:47]
    global_load_dwordx4 v[72:75], v12, s[36:37] offset:2752
    ds_read_b128 v[116:119], v15 offset:96
    s_waitcnt vmcnt(6) lgkmcnt(3)
    v_mfma_f32_32x32x16_bf16 v[32:47], v[48:51], v[104:107], v[32:47]
    global_load_dwordx4 v[76:79], v12, s[36:37] offset:2784
    ds_read_b128 v[104:107], v14 offset:80
    s_waitcnt vmcnt(6) lgkmcnt(3)
    v_mfma_f32_32x32x16_bf16 v[32:47], v[52:55], v[108:111], v[32:47]
    global_load_dwordx4 v[48:51], v12, s[36:37] offset:2816
    ds_read_b128 v[108:111], v15 offset:80
    s_waitcnt vmcnt(6) lgkmcnt(3)
    v_mfma_f32_32x32x16_bf16 v[32:47], v[56:59], v[112:115], v[32:47]
    global_load_dwordx4 v[52:55], v12, s[36:37] offset:2848
    ds_read_b128 v[112:115], v14 offset:64
    s_waitcnt vmcnt(6) lgkmcnt(3)
    v_mfma_f32_32x32x16_bf16 v[32:47], v[60:63], v[116:119], v[32:47]
    global_load_dwordx4 v[56:59], v12, s[36:37] offset:2880
    ds_read_b128 v[116:119], v15 offset:64
    s_waitcnt vmcnt(6) lgkmcnt(3)
    v_mfma_f32_32x32x16_bf16 v[32:47], v[64:67], v[104:107], v[32:47]
    global_load_dwordx4 v[60:63], v12, s[36:37] offset:2912
    ds_read_b128 v[104:107], v14 offset:48
    s_waitcnt vmcnt(6) lgkmcnt(3)
    v_mfma_f32_32x32x16_bf16 v[32:47], v[68:71], v[108:111], v[32:47]
    global_load_dwordx4 v[64:67], v12, s[36:37] offset:2944
    ds_read_b128 v[108:111], v15 offset:48
    s_waitcnt vmcnt(6) lgkmcnt(3)
    v_mfma_f32_32x32x16_bf16 v[32:47], v[72:75], v[112:115], v[32:47]
    global_load_dwordx4 v[68:71], v12, s[36:37] offset:2976
    ds_read_b128 v[112:115], v14 offset:32
    s_waitcnt vmcnt(6) lgkmcnt(3)
    v_mfma_f32_32x32x16_bf16 v[32:47], v[76:79], v[116:119], v[32:47]
    global_load_dwordx4 v[72:75], v12, s[36:37] offset:3008
    ds_read_b128 v[116:119], v15 offset:32
    s_waitcnt vmcnt(6) lgkmcnt(3)
    v_mfma_f32_32x32x16_bf16 v[32:47], v[48:51], v[104:107], v[32:47]
    global_load_dwordx4 v[76:79], v12, s[36:37] offset:3040
    ds_read_b128 v[104:107], v14 offset:16
    s_waitcnt vmcnt(6) lgkmcnt(3)
    v_mfma_f32_32x32x16_bf16 v[32:47], v[52:55], v[108:111], v[32:47]
    ds_read_b128 v[108:111], v15 offset:16
    s_waitcnt vmcnt(5) lgkmcnt(3)
    v_mfma_f32_32x32x16_bf16 v[32:47], v[56:59], v[112:115], v[32:47]
    ds_read_b128 v[112:115], v14 offset:0
    s_waitcnt vmcnt(4) lgkmcnt(3)
    v_mfma_f32_32x32x16_bf16 v[32:47], v[60:63], v[116:119], v[32:47]
    ds_read_b128 v[116:119], v15 offset:0
    s_waitcnt vmcnt(3) lgkmcnt(3)
    v_mfma_f32_32x32x16_bf16 v[32:47], v[64:67], v[104:107], v[32:47]
    s_waitcnt vmcnt(2) lgkmcnt(2)
    v_mfma_f32_32x32x16_bf16 v[32:47], v[68:71], v[108:111], v[32:47]
    s_waitcnt vmcnt(1) lgkmcnt(1)
    v_mfma_f32_32x32x16_bf16 v[32:47], v[72:75], v[112:115], v[32:47]
    s_waitcnt vmcnt(0) lgkmcnt(0)
    v_mfma_f32_32x32x16_bf16 v[32:47], v[76:79], v[116:119], v[32:47]
    s_setprio 3
    s_lshl_b32 s40, s28, 12
    s_add_u32 s40, s40, 143360
    v_add_u32 v6, s40, v3
    s_lshl_b32 s41, s28, 2
    s_add_u32 s41, s41, 161832
    v_mov_b32 v9, s41
    v_mul_u32_u24 v7, 1536, v5
    v_lshl_add_u32 v7, v4, 4, v7
    v_add_u32 v7, s33, v7
    ds_read_b128 v[64:67], v7 offset:1024
    ds_read_b128 v[68:71], v7 offset:4096
    v_lshlrev_b32 v8, 10, v5
    v_lshl_add_u32 v8, v4, 4, v8
    s_lshl_b32 s43, s30, 12
    s_add_u32 s43, s43, 15729152
    v_add_u32 v8, s43, v8
    s_nop 5
    s_mov_b32 s45, 0x400000
CV_SPIN:
    ds_read_b32 v10, v9
    s_sub_u32 s45, s45, 1
    s_waitcnt lgkmcnt(0)
    v_readfirstlane_b32 s42, v10
    s_cmp_eq_u32 s45, 0
    s_cbranch_scc1 CV_GO
    s_cmp_lg_u32 s42, 0
    s_cbranch_scc1 CV_GO
    s_sleep 1
    s_branch CV_SPIN
CV_GO:
    ds_read_b128 v[48:51], v6 offset:0
    ds_read_b128 v[52:55], v6 offset:1024
    ds_read_b128 v[56:59], v6 offset:2048
    ds_read_b128 v[60:63], v6 offset:3072
    s_waitcnt lgkmcnt(0)
    v_add_f32 v32, v32, v48
    v_add_f32 v33, v33, v49
    v_add_f32 v34, v34, v50
    v_add_f32 v35, v35, v51
    v_add_f32 v36, v36, v52
    v_add_f32 v37, v37, v53
    v_add_f32 v38, v38, v54
    v_add_f32 v39, v39, v55
    v_add_f32 v40, v40, v56
    v_add_f32 v41, v41, v57
    v_add_f32 v42, v42, v58
    v_add_f32 v43, v43, v59
    v_add_f32 v44, v44, v60
    v_add_f32 v45, v45, v61
    v_add_f32 v46, v46, v62
    v_add_f32 v47, v47, v63
    s_waitcnt lgkmcnt(0)
    v_and_b32 v80, 0xffff0000, v67
    v_lshlrev_b32 v81, 16, v67
    v_fma_f32 v80, v80, v13, v32
    v_fma_f32 v81, v81, v13, v40
    v_cvt_pk_bf16_f32 v88, v80, v81
    v_and_b32 v82, 0xffff0000, v66
    v_lshlrev_b32 v83, 16, v66
    v_fma_f32 v82, v82, v13, v33
    v_fma_f32 v83, v83, v13, v41
    v_cvt_pk_bf16_f32 v89, v82, v83
    v_and_b32 v80, 0xffff0000, v65
    v_lshlrev_b32 v81, 16, v65
    v_fma_f32 v80, v80, v13, v34
    v_fma_f32 v81, v81, v13, v42
    v_cvt_pk_bf16_f32 v90, v80, v81
    v_and_b32 v82, 0xffff0000, v64
    v_lshlrev_b32 v83, 16, v64
    v_fma_f32 v82, v82, v13, v35
    v_fma_f32 v83, v83, v13, v43
    v_cvt_pk_bf16_f32 v91, v82, v83
    global_store_dwordx4 v8, v[88:91], s[62:63] offset:0 sc1
    v_and_b32 v80, 0xffff0000, v71
    v_lshlrev_b32 v81, 16, v71
    v_fma_f32 v80, v80, v13, v36
    v_fma_f32 v81, v81, v13, v44
    v_cvt_pk_bf16_f32 v92, v80, v81
    v_and_b32 v82, 0xffff0000, v70
    v_lshlrev_b32 v83, 16, v70
    v_fma_f32 v82, v82, v13, v37
    v_fma_f32 v83, v83, v13, v45
    v_cvt_pk_bf16_f32 v93, v82, v83
    v_and_b32 v80, 0xffff0000, v69
    v_lshlrev_b32 v81, 16, v69
    v_fma_f32 v80, v80, v13, v38
    v_fma_f32 v81, v81, v13, v46
    v_cvt_pk_bf16_f32 v94, v80, v81
    v_and_b32 v82, 0xffff0000, v68
    v_lshlrev_b32 v83, 16, v68
    v_fma_f32 v82, v82, v13, v39
    v_fma_f32 v83, v83, v13, v47
    v_cvt_pk_bf16_f32 v95, v82, v83
    global_store_dwordx4 v8, v[92:95], s[62:63] offset:2048 sc1
CV_DONE:
    s_waitcnt vmcnt(0)
    s_waitcnt lgkmcnt(0)
    v_mov_b32 v4, 161812
    v_mov_b32 v5, 1
    s_mov_b64 exec, 1
    ds_add_u32 v4, v5
    s_mov_b64 exec, -1
    s_waitcnt lgkmcnt(0)
    v_mov_b32 v4, 161824
    v_mov_b32 v5, 1
    s_mov_b64 exec, 1
    ds_add_u32 v4, v5
    s_mov_b64 exec, -1
    s_cmp_lg_u32 s27, 0
    s_cbranch_scc1 B_NOY
    v_mov_b32 v4, 161812
    s_mov_b32 s52, 0x400000
LW_CV:
    ds_read_b32 v5, v4
    s_sub_u32 s52, s52, 1
    s_waitcnt lgkmcnt(0)
    v_readfirstlane_b32 s51, v5
    s_cmp_eq_u32 s52, 0
    s_cbranch_scc1 LWD_CV
    s_cmp_ge_u32 s51, 4
    s_cbranch_scc1 LWD_CV
    s_sleep 1
    s_branch LW_CV
LWD_CV:
    s_lshl_b32 s51, s25, 5
    s_add_u32 s51, s51, s26
    s_lshl_b32 s51, s51, 2
    s_add_u32 s51, s51, 18879488
    v_mov_b32 v4, s51
    v_mov_b32 v5, s60
    s_mov_b64 exec, 1
    global_store_dword v4, v5, s[62:63] sc1
    s_mov_b64 exec, -1
    s_load_dwordx2 s[8:9], s[0:1], 80
    s_lshl_b32 s51, s25, 7
    s_add_u32 s51, s51, 18879488
    v_and_b32 v8, 31, v2
    v_lshlrev_b32 v8, 2, v8
    v_add_u32 v8, s51, v8
    s_mov_b32 s52, 0x100000
GP_E3:
    global_load_dword v9, v8, s[62:63] sc1
    s_sub_u32 s52, s52, 1
    s_waitcnt vmcnt(0)
    v_cmp_eq_u32 vcc, s60, v9
    s_cmp_eq_u32 s52, 0
    s_cbranch_scc1 GPD_E3
    s_cmp_eq_u64 vcc, exec
    s_cbranch_scc0 GP_E3
GPD_E3:
    s_and_b32 s51, s26, 3
    s_lshr_b32 s52, s26, 2
    v_and_b32 v16, 7, v2
    v_lshrrev_b32 v17, 3, v2
    s_lshl_b32 s53, s25, 18
    s_lshl_b32 s54, s51, 10
    s_add_u32 s53, s53, s54
    s_lshl_b32 s54, s52, 7
    s_add_u32 s53, s53, s54
    s_add_u32 s53, s53, 15728640
    v_lshlrev_b32 v18, 15, v17
    v_lshl_add_u32 v18, v16, 4, v18
    v_add_u32 v18, s53, v18
    global_load_dwordx4 v[32:35], v18, s[62:63] sc1
    v_add_u32 v18, 0x1000, v18
    global_load_dwordx4 v[36:39], v18, s[62:63] sc1
    v_add_u32 v18, 0x1000, v18
    global_load_dwordx4 v[40:43], v18, s[62:63] sc1
    v_add_u32 v18, 0x1000, v18
    global_load_dwordx4 v[44:47], v18, s[62:63] sc1
    v_add_u32 v18, 0x1000, v18
    global_load_dwordx4 v[48:51], v18, s[62:63] sc1
    v_add_u32 v18, 0x1000, v18
    global_load_dwordx4 v[52:55], v18, s[62:63] sc1
    v_add_u32 v18, 0x1000, v18
    global_load_dwordx4 v[56:59], v18, s[62:63] sc1
    v_add_u32 v18, 0x1000, v18
    global_load_dwordx4 v[60:63], v18, s[62:63] sc1
    s_lshl_b32 s53, s52, 8
    s_lshl_b32 s54, s51, 3
    s_add_u32 s53, s53, s54
    v_lshlrev_b32 v19, 5, v17
    v_add_u32 v19, s53, v19
    v_lshlrev_b32 v19, 11, v19
    v_lshl_add_u32 v19, v16, 4, v19
    s_lshl_b32 s53, s25, 7
    s_add_u32 s53, s53, 1024
    v_add_u32 v19, s53, v19
    v_lshlrev_b32 v20, 7, v16
    v_lshl_add_u32 v20, v17, 4, v20
    v_add_u32 v20, 131072, v20
    v_lshlrev_b32 v21, 4, v2
    v_add_u32 v21, 131072, v21
    s_mov_b32 s54, 0x05040100
    s_mov_b32 s55, 0x07060302
    s_waitcnt vmcnt(0) lgkmcnt(0)
    v_perm_b32 v64, v36, v32, s54
    v_perm_b32 v65, v44, v40, s54
    v_perm_b32 v66, v52, v48, s54
    v_perm_b32 v67, v60, v56, s54
    ds_write_b128 v20, v[64:67] offset:0
    v_perm_b32 v68, v36, v32, s55
    v_perm_b32 v69, v44, v40, s55
    v_perm_b32 v70, v52, v48, s55
    v_perm_b32 v71, v60, v56, s55
    ds_write_b128 v20, v[68:71] offset:1024
    v_perm_b32 v72, v37, v33, s54
    v_perm_b32 v73, v45, v41, s54
    v_perm_b32 v74, v53, v49, s54
    v_perm_b32 v75, v61, v57, s54
    ds_write_b128 v20, v[72:75] offset:2048
    v_perm_b32 v76, v37, v33, s55
    v_perm_b32 v77, v45, v41, s55
    v_perm_b32 v78, v53, v49, s55
    v_perm_b32 v79, v61, v57, s55
    ds_write_b128 v20, v[76:79] offset:3072
    v_perm_b32 v64, v38, v34, s54
    v_perm_b32 v65, v46, v42, s54
    v_perm_b32 v66, v54, v50, s54
    v_perm_b32 v67, v62, v58, s54
    ds_write_b128 v20, v[64:67] offset:4096
    v_perm_b32 v68, v38, v34, s55
    v_perm_b32 v69, v46, v42, s55
    v_perm_b32 v70, v54, v50, s55
    v_perm_b32 v71, v62, v58, s55
    ds_write_b128 v20, v[68:71] offset:5120
    v_perm_b32 v72, v39, v35, s54
    v_perm_b32 v73, v47, v43, s54
    v_perm_b32 v74, v55, v51, s54
    v_perm_b32 v75, v63, v59, s54
    ds_write_b128 v20, v[72:75] offset:6144
    v_perm_b32 v76, v39, v35, s55
    v_perm_b32 v77, v47, v43, s55
    v_perm_b32 v78, v55, v51, s55
    v_perm_b32 v79, v63, v59, s55
    ds_write_b128 v20, v[76:79] offset:7168
    s_waitcnt lgkmcnt(0)
    ds_read_b128 v[32:35], v21 offset:0
    ds_read_b128 v[36:39], v21 offset:1024
    ds_read_b128 v[40:43], v21 offset:2048
    ds_read_b128 v[44:47], v21 offset:3072
    ds_read_b128 v[48:51], v21 offset:4096
    ds_read_b128 v[52:55], v21 offset:5120
    ds_read_b128 v[56:59], v21 offset:6144
    ds_read_b128 v[60:63], v21 offset:7168
    s_waitcnt lgkmcnt(7)
    global_store_dwordx4 v19, v[32:35], s[8:9]
    v_add_u32 v19, 0x800, v19
    s_waitcnt lgkmcnt(6)
    global_store_dwordx4 v19, v[36:39], s[8:9]
    v_add_u32 v19, 0x800, v19
    s_waitcnt lgkmcnt(5)
    global_store_dwordx4 v19, v[40:43], s[8:9]
    v_add_u32 v19, 0x800, v19
    s_waitcnt lgkmcnt(4)
    global_store_dwordx4 v19, v[44:47], s[8:9]
    v_add_u32 v19, 0x800, v19
    s_waitcnt lgkmcnt(3)
    global_store_dwordx4 v19, v[48:51], s[8:9]
    v_add_u32 v19, 0x800, v19
    s_waitcnt lgkmcnt(2)
    global_store_dwordx4 v19, v[52:55], s[8:9]
    v_add_u32 v19, 0x800, v19
    s_waitcnt lgkmcnt(1)
    global_store_dwordx4 v19, v[56:59], s[8:9]
    v_add_u32 v19, 0x800, v19
    s_waitcnt lgkmcnt(0)
    global_store_dwordx4 v19, v[60:63], s[8:9]
B_NOY:
    s_load_dwordx2 s[4:5], s[0:1], 16
    s_lshl_b32 s51, s26, 14
    s_lshl_b32 s52, s27, 12
    s_add_u32 s51, s51, s52
    v_and_b32 v4, 31, v2
    v_lshlrev_b32 v4, 7, v4
    v_add_u32 v4, s51, v4
    s_waitcnt lgkmcnt(0)
    global_load_dword v150, v4, s[4:5]
    s_setprio 0
    s_load_dwordx2 s[4:5], s[0:1], 16
    s_lshl_b32 s27, s25, 3
    s_and_b32 s28, s26, 7
    s_add_u32 s27, s27, s28
    s_lshr_b32 s28, s26, 3
    s_sub_u32 s23, s24, 8
    v_lshrrev_b32 v4, 4, v2
    v_and_b32 v5, 15, v2
    v_lshlrev_b32 v6, 2, v4
    v_xor_b32 v5, v5, v6
    v_lshlrev_b32 v4, 10, v4
    v_lshl_add_u32 v4, v5, 4, v4
    s_lshl_b32 s34, s23, 16
    s_lshl_b32 s35, s23, 15
    s_lshl_b32 s29, s28, 8
    s_waitcnt lgkmcnt(0)
    s_add_u32 s4, s4, s29
    s_addc_u32 s5, s5, 0
    s_mov_b32 s16, s4
    s_and_b32 s17, s5, 0xffff
    s_sub_u32 s18, 524288, s29
    s_mov_b32 s19, 0x20000
    v_lshlrev_b32 v3, 4, v2
    s_lshl_b32 s32, s27, 5
    s_lshl_b32 s33, s23, 1
    s_add_u32 s32, s32, s33
    s_lshl_b32 s32, s32, 10
    s_add_u32 s32, s32, 6291456
    s_lshl_b32 s33, s23, 11
    s_add_u32 s33, s33, 131072
    s_mov_b32 s12, s62
    s_and_b32 s13, s63, 0xffff
    s_mov_b32 s14, 8388608
    s_mov_b32 s15, 0x20000
    v_mov_b32 v6, 161820
    ds_read_b32 v7, v6
    s_waitcnt lgkmcnt(0)
    v_readfirstlane_b32 s60, v7
    s_nop 3
    v_mov_b32 v6, 161856
    v_and_b32 v7, 7, v2
    v_lshl_add_u32 v6, v7, 2, v6
    s_mov_b32 s52, 0x400000
P3L_PW:
    ds_read_b32 v7, v6
    s_sub_u32 s52, s52, 1
    s_waitcnt lgkmcnt(0)
    v_cmp_le_u32 vcc, 16, v7
    s_cmp_eq_u32 s52, 0
    s_cbranch_scc1 P3L_PD
    s_cmp_eq_u64 vcc, exec
    s_cbranch_scc1 P3L_PD
    s_sleep 8
    s_branch P3L_PW
P3L_PD:
    s_add_u32 m0, s35, 0
    s_add_u32 s36, s34, 0
    buffer_load_dwordx4 v4, s[16:19], s36 offen lds
    s_add_u32 m0, s35, 1024
    s_add_u32 s36, s34, 4096
    buffer_load_dwordx4 v4, s[16:19], s36 offen lds
    s_add_u32 m0, s35, 2048
    s_add_u32 s36, s34, 8192
    buffer_load_dwordx4 v4, s[16:19], s36 offen lds
    s_add_u32 m0, s35, 3072
    s_add_u32 s36, s34, 12288
    buffer_load_dwordx4 v4, s[16:19], s36 offen lds
    s_add_u32 m0, s35, 4096
    s_add_u32 s36, s34, 16384
    buffer_load_dwordx4 v4, s[16:19], s36 offen lds
    s_add_u32 m0, s35, 5120
    s_add_u32 s36, s34, 20480
    buffer_load_dwordx4 v4, s[16:19], s36 offen lds
    s_add_u32 m0, s35, 6144
    s_add_u32 s36, s34, 24576
    buffer_load_dwordx4 v4, s[16:19], s36 offen lds
    s_add_u32 m0, s35, 7168
    s_add_u32 s36, s34, 28672
    buffer_load_dwordx4 v4, s[16:19], s36 offen lds
    s_add_u32 m0, s35, 8192
    s_add_u32 s36, s34, 32768
    buffer_load_dwordx4 v4, s[16:19], s36 offen lds
    s_add_u32 m0, s35, 9216
    s_add_u32 s36, s34, 36864
    buffer_load_dwordx4 v4, s[16:19], s36 offen lds
    s_add_u32 m0, s35, 10240
    s_add_u32 s36, s34, 40960
    buffer_load_dwordx4 v4, s[16:19], s36 offen lds
    s_add_u32 m0, s35, 11264
    s_add_u32 s36, s34, 45056
    buffer_load_dwordx4 v4, s[16:19], s36 offen lds
    s_add_u32 m0, s35, 12288
    s_add_u32 s36, s34, 49152
    buffer_load_dwordx4 v4, s[16:19], s36 offen lds
    s_add_u32 m0, s35, 13312
    s_add_u32 s36, s34, 53248
    buffer_load_dwordx4 v4, s[16:19], s36 offen lds
    s_add_u32 m0, s35, 14336
    s_add_u32 s36, s34, 57344
    buffer_load_dwordx4 v4, s[16:19], s36 offen lds
    s_add_u32 m0, s35, 15360
    s_add_u32 s36, s34, 61440
    buffer_load_dwordx4 v4, s[16:19], s36 offen lds
    s_lshl_b32 s51, s27, 7
    s_add_u32 s51, s51, 18882560
    s_barrier
    v_mov_b32 v6, 161792
    ds_read_b32 v7, v6
    s_waitcnt lgkmcnt(0)
    v_readfirstlane_b32 s36, v7
    s_nop 3
    s_cmp_eq_u32 s36, 0
    s_cbranch_scc1 P3L_NOFB
    s_waitcnt vmcnt(0)
    s_lshr_b32 s40, s23, 1
    s_and_b32 s41, s23, 1
    s_lshl_b32 s42, s25, 2
    s_and_b32 s43, s26, 3
    s_add_u32 s42, s42, s43
    s_lshl_b32 s42, s42, 6
    s_lshl_b32 s43, s40, 5
    s_add_u32 s42, s42, s43
    s_lshl_b32 s42, s42, 10
    s_mul_i32 s43, s41, 2097152
    s_add_u32 s42, s42, s43
    s_add_u32 s42, s42, 2097152
    s_add_u32 m0, s35, 0
    s_add_u32 s36, s42, 0
    buffer_load_dwordx4 v3, s[12:15], s36 offen sc1 lds
    s_add_u32 m0, s35, 1024
    s_add_u32 s36, s42, 1024
    buffer_load_dwordx4 v3, s[12:15], s36 offen sc1 lds
    s_add_u32 m0, s35, 2048
    s_add_u32 s36, s42, 2048
    buffer_load_dwordx4 v3, s[12:15], s36 offen sc1 lds
    s_add_u32 m0, s35, 3072
    s_add_u32 s36, s42, 3072
    buffer_load_dwordx4 v3, s[12:15], s36 offen sc1 lds
    s_add_u32 m0, s35, 4096
    s_add_u32 s36, s42, 4096
    buffer_load_dwordx4 v3, s[12:15], s36 offen sc1 lds
    s_add_u32 m0, s35, 5120
    s_add_u32 s36, s42, 5120
    buffer_load_dwordx4 v3, s[12:15], s36 offen sc1 lds
    s_add_u32 m0, s35, 6144
    s_add_u32 s36, s42, 6144
    buffer_load_dwordx4 v3, s[12:15], s36 offen sc1 lds
    s_add_u32 m0, s35, 7168
    s_add_u32 s36, s42, 7168
    buffer_load_dwordx4 v3, s[12:15], s36 offen sc1 lds
    s_add_u32 m0, s35, 8192
    s_add_u32 s36, s42, 8192
    buffer_load_dwordx4 v3, s[12:15], s36 offen sc1 lds
    s_add_u32 m0, s35, 9216
    s_add_u32 s36, s42, 9216
    buffer_load_dwordx4 v3, s[12:15], s36 offen sc1 lds
    s_add_u32 m0, s35, 10240
    s_add_u32 s36, s42, 10240
    buffer_load_dwordx4 v3, s[12:15], s36 offen sc1 lds
    s_add_u32 m0, s35, 11264
    s_add_u32 s36, s42, 11264
    buffer_load_dwordx4 v3, s[12:15], s36 offen sc1 lds
    s_add_u32 m0, s35, 12288
    s_add_u32 s36, s42, 12288
    buffer_load_dwordx4 v3, s[12:15], s36 offen sc1 lds
    s_add_u32 m0, s35, 13312
    s_add_u32 s36, s42, 13312
    buffer_load_dwordx4 v3, s[12:15], s36 offen sc1 lds
    s_add_u32 m0, s35, 14336
    s_add_u32 s36, s42, 14336
    buffer_load_dwordx4 v3, s[12:15], s36 offen sc1 lds
    s_add_u32 m0, s35, 15360
    s_add_u32 s36, s42, 15360
    buffer_load_dwordx4 v3, s[12:15], s36 offen sc1 lds
    s_waitcnt vmcnt(0)
    s_barrier
    s_barrier
    s_barrier
    s_barrier
    s_add_u32 m0, s35, 0
    s_add_u32 s36, s34, 0
    buffer_load_dwordx4 v4, s[16:19], s36 offen lds
    s_add_u32 m0, s35, 1024
    s_add_u32 s36, s34, 4096
    buffer_load_dwordx4 v4, s[16:19], s36 offen lds
    s_add_u32 m0, s35, 2048
    s_add_u32 s36, s34, 8192
    buffer_load_dwordx4 v4, s[16:19], s36 offen lds
    s_add_u32 m0, s35, 3072
    s_add_u32 s36, s34, 12288
    buffer_load_dwordx4 v4, s[16:19], s36 offen lds
    s_add_u32 m0, s35, 4096
    s_add_u32 s36, s34, 16384
    buffer_load_dwordx4 v4, s[16:19], s36 offen lds
    s_add_u32 m0, s35, 5120
    s_add_u32 s36, s34, 20480
    buffer_load_dwordx4 v4, s[16:19], s36 offen lds
    s_add_u32 m0, s35, 6144
    s_add_u32 s36, s34, 24576
    buffer_load_dwordx4 v4, s[16:19], s36 offen lds
    s_add_u32 m0, s35, 7168
    s_add_u32 s36, s34, 28672
    buffer_load_dwordx4 v4, s[16:19], s36 offen lds
    s_add_u32 m0, s35, 8192
    s_add_u32 s36, s34, 32768
    buffer_load_dwordx4 v4, s[16:19], s36 offen lds
    s_add_u32 m0, s35, 9216
    s_add_u32 s36, s34, 36864
    buffer_load_dwordx4 v4, s[16:19], s36 offen lds
    s_add_u32 m0, s35, 10240
    s_add_u32 s36, s34, 40960
    buffer_load_dwordx4 v4, s[16:19], s36 offen lds
    s_add_u32 m0, s35, 11264
    s_add_u32 s36, s34, 45056
    buffer_load_dwordx4 v4, s[16:19], s36 offen lds
    s_add_u32 m0, s35, 12288
    s_add_u32 s36, s34, 49152
    buffer_load_dwordx4 v4, s[16:19], s36 offen lds
    s_add_u32 m0, s35, 13312
    s_add_u32 s36, s34, 53248
    buffer_load_dwordx4 v4, s[16:19], s36 offen lds
    s_add_u32 m0, s35, 14336
    s_add_u32 s36, s34, 57344
    buffer_load_dwordx4 v4, s[16:19], s36 offen lds
    s_add_u32 m0, s35, 15360
    s_add_u32 s36, s34, 61440
    buffer_load_dwordx4 v4, s[16:19], s36 offen lds
P3L_NOFB:
    s_cmp_lg_u32 s23, 0
    s_cbranch_scc1 P3L_NP
    v_and_b32 v8, 31, v2
    v_lshlrev_b32 v8, 2, v8
    v_add_u32 v8, s51, v8
    s_mov_b32 s52, 0x100000
GP_E4:
    global_load_dword v9, v8, s[62:63] sc1
    s_sub_u32 s52, s52, 1
    s_waitcnt vmcnt(0)
    v_cmp_eq_u32 vcc, s60, v9
    s_cmp_eq_u32 s52, 0
    s_cbranch_scc1 GPD_E4
    s_cmp_eq_u64 vcc, exec
    s_cbranch_scc0 GP_E4
GPD_E4:
P3L_NP:
    s_barrier
    s_add_u32 m0, s33, 0
    s_add_u32 s36, s32, 0
    buffer_load_dwordx4 v3, s[12:15], s36 offen sc1 lds
    s_add_u32 m0, s33, 1024
    s_add_u32 s36, s32, 1024
    buffer_load_dwordx4 v3, s[12:15], s36 offen sc1 lds
    s_add_u32 m0, s33, 8192
    s_add_u32 s36, s32, 8192
    buffer_load_dwordx4 v3, s[12:15], s36 offen sc1 lds
    s_add_u32 m0, s33, 9216
    s_add_u32 s36, s32, 9216
    buffer_load_dwordx4 v3, s[12:15], s36 offen sc1 lds
    s_add_u32 m0, s33, 16384
    s_add_u32 s36, s32, 16384
    buffer_load_dwordx4 v3, s[12:15], s36 offen sc1 lds
    s_add_u32 m0, s33, 17408
    s_add_u32 s36, s32, 17408
    buffer_load_dwordx4 v3, s[12:15], s36 offen sc1 lds
    s_add_u32 m0, s33, 24576
    s_add_u32 s36, s32, 24576
    buffer_load_dwordx4 v3, s[12:15], s36 offen sc1 lds
    s_add_u32 m0, s33, 25600
    s_add_u32 s36, s32, 25600
    buffer_load_dwordx4 v3, s[12:15], s36 offen sc1 lds
    s_waitcnt vmcnt(0)
    s_barrier
KM_END:
    s_endpgm
.section .rodata,"a"
.p2align 6
.amdhsa_kernel concat_heads__mha_block__ssm_conv_s4d__prompt_kernel
  .amdhsa_next_free_vgpr 168
  .amdhsa_next_free_sgpr 96
  .amdhsa_accum_offset 168
  .amdhsa_group_segment_fixed_size 0
  .amdhsa_kernarg_size 104
  .amdhsa_user_sgpr_count 2
  .amdhsa_user_sgpr_kernarg_segment_ptr 1
  .amdhsa_system_sgpr_workgroup_id_x 1
.end_amdhsa_kernel
```
